```python
import torch

def _softmax(x, axis=-1):
    return torch.softmax(x, dim=axis)
def _gelu(x):
    return torch.nn.functional.gelu(x, approximate="tanh")
def _silu(x):
    return torch.nn.functional.silu(x)
def _sigmoid(x):
    return torch.sigmoid(x)
def _layernorm(x, axis=-1, eps=1e-5):
    m = x.mean(dim=axis, keepdim=True)
    v = x.var(dim=axis, keepdim=True, unbiased=False)
    return (x - m) / torch.sqrt(v + eps)
def _scatter_add(tgt, idx, src, axis=0):
    return tgt.clone().index_add_(axis, idx, src)
def _segment_sum(src, seg, n):
    out = torch.zeros((n,) + src.shape[1:], dtype=src.dtype)
    return out.index_add_(0, seg, src)
def _pad(x, pw):
    flat = tuple(v for pair in reversed(pw) for v in pair)
    return torch.nn.functional.pad(x, flat)

kernel_name = 'sequential_preLN__grouped_kv_mqa__glu_gated_reglu__prompt'

def setup_inputs():

    _w = (lambda a: (lambda t: t.to(torch.bfloat16) if t.is_floating_point() else t)(torch.as_tensor(a)))
    def _A_setup():
        B, S, D, H = 1, 2048, 512, 32
        Dh = D // H
        return {
            "x": _w((lambda *s: torch.randn(*s, dtype=torch.bfloat16) * 0.05)(B, S, D)),
            "wq": _w((lambda *s: torch.randn(*s, dtype=torch.bfloat16) * 0.05)(D, H * Dh)),
            "wk": _w((lambda *s: torch.randn(*s, dtype=torch.bfloat16) * 0.05)(D, Dh)),
            "wv": _w((lambda *s: torch.randn(*s, dtype=torch.bfloat16) * 0.05)(D, Dh)),
            "wo": _w((lambda *s: torch.randn(*s, dtype=torch.bfloat16) * 0.05)(H * Dh, D)),
        }
    _A_in = _A_setup()

    def _B_setup():
        B, S, D, F = 1, 2048, 512, 1792
        return {
            "x": _w((lambda *s: torch.randn(*s, dtype=torch.bfloat16) * 0.05)(B, S, D)),
            "W_gate": _w((lambda *s: torch.randn(*s, dtype=torch.bfloat16) * 0.4)(D, F) * (2.0 / D) ** 0.5),
            "W_up": _w((lambda *s: torch.randn(*s, dtype=torch.bfloat16) * 0.4)(D, F) * (2.0 / D) ** 0.5),
            "W_down": _w((lambda *s: torch.randn(*s, dtype=torch.bfloat16) * 0.4)(F, D) * (1.0 / F) ** 0.5),
        }
    _B_in = _B_setup()

    return {
        "A_x": _A_in["x"],
        "A_wq": _A_in["wq"],
        "A_wk": _A_in["wk"],
        "A_wv": _A_in["wv"],
        "A_wo": _A_in["wo"],
        "B_x": _B_in["x"],
        "B_W_gate": _B_in["W_gate"],
        "B_W_up": _B_in["W_up"],
        "B_W_down": _B_in["W_down"],
    }

def reference(A_x, A_wq, A_wk, A_wv, A_wo, B_x, B_W_gate, B_W_up, B_W_down):
    def _A_ref(x, wq, wk, wv, wo):
        B, S, D = x.shape
        H = 32
        Dh = D // H
        q = (lambda x, *d: x.permute(*d))((x @ wq).reshape(B, S, H, Dh), 0, 2, 1, 3)
        k = x @ wk
        v = x @ wv
        scores = torch.einsum("bhqd,bkd->bhqk", q, k) * (Dh ** -0.5)
        p = _softmax(scores, axis=-1)
        o = torch.einsum("bhqk,bkd->bhqd", p, v)
        return (lambda x, *d: x.permute(*d))(o, 0, 2, 1, 3).reshape(B, S, H * Dh) @ wo

    def _B_ref(x, W_gate, W_up, W_down):
        gate = torch.einsum("bsd,df->bsf", x, W_gate)
        up = torch.einsum("bsd,df->bsf", x, W_up)
        gate = gate * (lambda x, dt: x.to(dt))(gate > 0, gate.dtype)
        h = gate * up
        return torch.einsum("bsf,fd->bsd", h, W_down)

    x = A_x
    h = x + _A_ref(_layernorm(x, axis=-1), A_wq, A_wk, A_wv, A_wo)
    h2 = h + _B_ref(_layernorm(h, axis=-1), B_W_gate, B_W_up, B_W_down)
    return h2
```

```asm
; @launch grid=(256,1,1) block=(512,1,1) lds=163840
.amdgcn_target "amdgcn-amd-amdhsa--gfx950"
.text
.globl sequential_preLN__grouped_kv_mqa__glu_gated_reglu__prompt_kernel
.p2align 8
.type sequential_preLN__grouped_kv_mqa__glu_gated_reglu__prompt_kernel,@function
sequential_preLN__grouped_kv_mqa__glu_gated_reglu__prompt_kernel:
    s_cmp_ge_u32 s2, 256
    s_cbranch_scc1 L_fin
    s_load_dwordx16 s[16:31], s[0:1], 0
    s_load_dwordx8 s[32:39], s[0:1], 64
    v_lshrrev_b32 v1, 6, v0
    v_and_b32 v0, 63, v0
    v_readfirstlane_b32 s4, v1
    s_and_b32 s3, s2, 7
    s_lshr_b32 s5, s2, 3
    s_and_b32 s6, s5, 15
    s_lshr_b32 s5, s5, 4
    s_lshl_b32 s3, s3, 1
    s_add_u32 s5, s5, s3
    s_lshr_b32 s53, s6, 2
    s_and_b32 s52, s6, 3
    s_lshl_b32 s7, s5, 2
    s_add_u32 s7, s7, s53
    s_waitcnt lgkmcnt(0)
    s_mov_b32 s8, s38
    s_mov_b32 s9, s39
    s_mov_b32 s10, 0x1700000
    s_mov_b32 s11, 0x00020000
    s_add_u32 s60, s38, 24051712
    s_addc_u32 s61, s39, 0
    s_load_dword s56, s[60:61], 0
    s_mov_b32 s12, s16
    s_mov_b32 s13, s17
    s_mov_b32 s14, 0x200000
    s_mov_b32 s15, 0x00020000
    s_mov_b32 s40, s18
    s_mov_b32 s41, s19
    s_mov_b32 s42, 0x80000
    s_mov_b32 s43, 0x00020000
    s_lshl_b32 s54, s7, 5
    s_lshl_b32 s55, s4, 2
    s_add_u32 s54, s54, s55
    v_lshrrev_b32 v2, 4, v0
    v_and_b32 v3, 15, v0
    v_add_u32 v4, s54, v2
    v_lshlrev_b32 v4, 10, v4
    v_lshl_add_u32 v4, v3, 4, v4
    buffer_load_dwordx4 v[16:19], v4, s[12:15], 0 offen offset:0
    buffer_load_dwordx4 v[20:23], v4, s[12:15], 0 offen offset:256
    buffer_load_dwordx4 v[24:27], v4, s[12:15], 0 offen offset:512
    buffer_load_dwordx4 v[28:31], v4, s[12:15], 0 offen offset:768
    v_lshlrev_b32 v6, 4, v0
    s_mov_b32 s60, 0x320000
    buffer_load_dword v60, v6, s[8:11], s60 offen
    s_cmp_lg_u32 s52, 0
    s_cbranch_scc1 nokv_1
    s_mov_b32 s44, s20
    s_mov_b32 s45, s21
    s_mov_b32 s46, 0x4000
    s_mov_b32 s47, 0x00020000
    s_mov_b32 s48, s22
    s_mov_b32 s49, s23
    s_mov_b32 s50, 0x4000
    s_mov_b32 s51, 0x00020000
    s_lshl_b32 s60, s4, 11
    s_add_u32 s61, s60, 0
    s_add_u32 m0, s61, 131072
    s_nop 0
    buffer_load_dwordx4 v6, s[44:47], s61 offen lds
    s_add_u32 m0, s61, 147456
    s_nop 0
    buffer_load_dwordx4 v6, s[48:51], s61 offen lds
    s_add_u32 s61, s60, 1024
    s_add_u32 m0, s61, 131072
    s_nop 0
    buffer_load_dwordx4 v6, s[44:47], s61 offen lds
    s_add_u32 m0, s61, 147456
    s_nop 0
    buffer_load_dwordx4 v6, s[48:51], s61 offen lds
nokv_1:
    v_lshlrev_b32 v5, 2, v2
    v_xor_b32 v5, v3, v5
    v_lshlrev_b32 v5, 4, v5
    v_lshl_add_u32 v5, v2, 10, v5
    s_lshl_b32 s55, s52, 8
    v_add_u32 v5, s55, v5
    s_lshl_b32 s62, s4, 12
    s_add_u32 s62, s62, 32768
    s_lshl_b32 s63, s4, 14
    s_add_u32 m0, s62, 0
    s_add_u32 s64, s63, 0
    buffer_load_dwordx4 v5, s[40:43], s64 offen lds
    s_add_u32 m0, s62, 1024
    s_add_u32 s64, s63, 4096
    buffer_load_dwordx4 v5, s[40:43], s64 offen lds
    s_add_u32 m0, s62, 2048
    s_add_u32 s64, s63, 8192
    buffer_load_dwordx4 v5, s[40:43], s64 offen lds
    s_add_u32 m0, s62, 3072
    s_add_u32 s64, s63, 12288
    buffer_load_dwordx4 v5, s[40:43], s64 offen lds
    s_waitcnt vmcnt(4)
    s_mov_b32 s60, 0x3f803f80
    v_mov_b32 v32, 0
    v_mov_b32 v33, 0
    v_mov_b32 v34, 0
    v_mov_b32 v35, 0
    v_dot2_f32_bf16 v32, v16, s60, v32
    v_dot2_f32_bf16 v34, v16, v16, v34
    v_dot2_f32_bf16 v33, v17, s60, v33
    v_dot2_f32_bf16 v35, v17, v17, v35
    v_dot2_f32_bf16 v32, v18, s60, v32
    v_dot2_f32_bf16 v34, v18, v18, v34
    v_dot2_f32_bf16 v33, v19, s60, v33
    v_dot2_f32_bf16 v35, v19, v19, v35
    v_dot2_f32_bf16 v32, v20, s60, v32
    v_dot2_f32_bf16 v34, v20, v20, v34
    v_dot2_f32_bf16 v33, v21, s60, v33
    v_dot2_f32_bf16 v35, v21, v21, v35
    v_dot2_f32_bf16 v32, v22, s60, v32
    v_dot2_f32_bf16 v34, v22, v22, v34
    v_dot2_f32_bf16 v33, v23, s60, v33
    v_dot2_f32_bf16 v35, v23, v23, v35
    v_dot2_f32_bf16 v32, v24, s60, v32
    v_dot2_f32_bf16 v34, v24, v24, v34
    v_dot2_f32_bf16 v33, v25, s60, v33
    v_dot2_f32_bf16 v35, v25, v25, v35
    v_dot2_f32_bf16 v32, v26, s60, v32
    v_dot2_f32_bf16 v34, v26, v26, v34
    v_dot2_f32_bf16 v33, v27, s60, v33
    v_dot2_f32_bf16 v35, v27, v27, v35
    v_dot2_f32_bf16 v32, v28, s60, v32
    v_dot2_f32_bf16 v34, v28, v28, v34
    v_dot2_f32_bf16 v33, v29, s60, v33
    v_dot2_f32_bf16 v35, v29, v29, v35
    v_dot2_f32_bf16 v32, v30, s60, v32
    v_dot2_f32_bf16 v34, v30, v30, v34
    v_dot2_f32_bf16 v33, v31, s60, v33
    v_dot2_f32_bf16 v35, v31, v31, v35
    s_mov_b32 s61, 0xffff0000
    v_lshlrev_b32 v64, 16, v16
    v_and_b32 v65, s61, v16
    v_lshlrev_b32 v66, 16, v17
    v_and_b32 v67, s61, v17
    v_lshlrev_b32 v68, 16, v18
    v_and_b32 v69, s61, v18
    v_lshlrev_b32 v70, 16, v19
    v_and_b32 v71, s61, v19
    v_add_f32 v32, v32, v33
    v_add_f32 v34, v34, v35
    v_lshlrev_b32 v72, 16, v20
    v_and_b32 v73, s61, v20
    v_lshlrev_b32 v74, 16, v21
    v_and_b32 v75, s61, v21
    v_lshlrev_b32 v76, 16, v22
    v_and_b32 v77, s61, v22
    v_add_f32_dpp v32, v32, v32 row_ror:8 row_mask:0xf bank_mask:0xf
    v_add_f32_dpp v34, v34, v34 row_ror:8 row_mask:0xf bank_mask:0xf
    v_lshlrev_b32 v78, 16, v23
    v_and_b32 v79, s61, v23
    v_lshlrev_b32 v80, 16, v24
    v_and_b32 v81, s61, v24
    v_lshlrev_b32 v82, 16, v25
    v_and_b32 v83, s61, v25
    v_add_f32_dpp v32, v32, v32 row_ror:4 row_mask:0xf bank_mask:0xf
    v_add_f32_dpp v34, v34, v34 row_ror:4 row_mask:0xf bank_mask:0xf
    v_lshlrev_b32 v84, 16, v26
    v_and_b32 v85, s61, v26
    v_lshlrev_b32 v86, 16, v27
    v_and_b32 v87, s61, v27
    v_lshlrev_b32 v88, 16, v28
    v_and_b32 v89, s61, v28
    v_add_f32_dpp v32, v32, v32 row_ror:2 row_mask:0xf bank_mask:0xf
    v_add_f32_dpp v34, v34, v34 row_ror:2 row_mask:0xf bank_mask:0xf
    v_lshlrev_b32 v90, 16, v29
    v_and_b32 v91, s61, v29
    v_lshlrev_b32 v92, 16, v30
    v_and_b32 v93, s61, v30
    v_lshlrev_b32 v94, 16, v31
    v_and_b32 v95, s61, v31
    v_add_f32_dpp v32, v32, v32 row_ror:1 row_mask:0xf bank_mask:0xf
    v_add_f32_dpp v34, v34, v34 row_ror:1 row_mask:0xf bank_mask:0xf
    v_mul_f32 v32, 0x3b000000, v32
    v_mul_f32 v33, v32, v32
    v_mov_b32 v35, 0x3b000000
    v_fma_f32 v34, v34, v35, -v33
    v_max_f32 v34, 0, v34
    v_add_f32 v34, 0x3727c5ac, v34
    v_rsq_f32 v38, v34
    s_lshl_b32 s55, s4, 2
    v_add_u32 v7, s55, v2
    v_mov_b32 v39, v38
    v_mul_f32 v36, v32, v38
    v_sub_f32 v36, 0, v36
    v_mov_b32 v37, v36
    v_pk_fma_f32 v[64:65], v[64:65], v[38:39], v[36:37]
    v_pk_fma_f32 v[66:67], v[66:67], v[38:39], v[36:37]
    v_pk_fma_f32 v[68:69], v[68:69], v[38:39], v[36:37]
    v_pk_fma_f32 v[70:71], v[70:71], v[38:39], v[36:37]
    v_pk_fma_f32 v[72:73], v[72:73], v[38:39], v[36:37]
    v_pk_fma_f32 v[74:75], v[74:75], v[38:39], v[36:37]
    v_pk_fma_f32 v[76:77], v[76:77], v[38:39], v[36:37]
    v_pk_fma_f32 v[78:79], v[78:79], v[38:39], v[36:37]
    v_pk_fma_f32 v[80:81], v[80:81], v[38:39], v[36:37]
    v_pk_fma_f32 v[82:83], v[82:83], v[38:39], v[36:37]
    v_pk_fma_f32 v[84:85], v[84:85], v[38:39], v[36:37]
    v_pk_fma_f32 v[86:87], v[86:87], v[38:39], v[36:37]
    v_pk_fma_f32 v[88:89], v[88:89], v[38:39], v[36:37]
    v_pk_fma_f32 v[90:91], v[90:91], v[38:39], v[36:37]
    v_pk_fma_f32 v[92:93], v[92:93], v[38:39], v[36:37]
    v_pk_fma_f32 v[94:95], v[94:95], v[38:39], v[36:37]
    v_and_b32 v8, 7, v3
    v_xor_b32 v7, v7, v8
    v_lshlrev_b32 v7, 4, v7
    v_lshrrev_b32 v8, 1, v3
    v_lshl_add_u32 v7, v8, 10, v7
    v_and_b32 v8, 1, v3
    v_lshl_add_u32 v7, v8, 9, v7
    v_cvt_pk_bf16_f32 v16, v64, v65
    v_cvt_pk_bf16_f32 v17, v66, v67
    v_cvt_pk_bf16_f32 v18, v68, v69
    v_cvt_pk_bf16_f32 v19, v70, v71
    ds_write_b128 v7, v[16:19] offset:0
    v_cvt_pk_bf16_f32 v20, v72, v73
    v_cvt_pk_bf16_f32 v21, v74, v75
    v_cvt_pk_bf16_f32 v22, v76, v77
    v_cvt_pk_bf16_f32 v23, v78, v79
    ds_write_b128 v7, v[20:23] offset:8192
    v_cvt_pk_bf16_f32 v24, v80, v81
    v_cvt_pk_bf16_f32 v25, v82, v83
    v_cvt_pk_bf16_f32 v26, v84, v85
    v_cvt_pk_bf16_f32 v27, v86, v87
    ds_write_b128 v7, v[24:27] offset:16384
    v_cvt_pk_bf16_f32 v28, v88, v89
    v_cvt_pk_bf16_f32 v29, v90, v91
    v_cvt_pk_bf16_f32 v30, v92, v93
    v_cvt_pk_bf16_f32 v31, v94, v95
    ds_write_b128 v7, v[28:31] offset:24576
    s_add_u32 m0, s62, 32768
    s_add_u32 s64, s63, 131072
    buffer_load_dwordx4 v5, s[40:43], s64 offen lds
    s_add_u32 m0, s62, 33792
    s_add_u32 s64, s63, 135168
    buffer_load_dwordx4 v5, s[40:43], s64 offen lds
    s_add_u32 m0, s62, 34816
    s_add_u32 s64, s63, 139264
    buffer_load_dwordx4 v5, s[40:43], s64 offen lds
    s_add_u32 m0, s62, 35840
    s_add_u32 s64, s63, 143360
    buffer_load_dwordx4 v5, s[40:43], s64 offen lds
    s_add_u32 m0, s62, 65536
    s_add_u32 s64, s63, 262144
    buffer_load_dwordx4 v5, s[40:43], s64 offen lds
    s_add_u32 m0, s62, 66560
    s_add_u32 s64, s63, 266240
    buffer_load_dwordx4 v5, s[40:43], s64 offen lds
    s_add_u32 m0, s62, 67584
    s_add_u32 s64, s63, 270336
    buffer_load_dwordx4 v5, s[40:43], s64 offen lds
    s_add_u32 m0, s62, 68608
    s_add_u32 s64, s63, 274432
    buffer_load_dwordx4 v5, s[40:43], s64 offen lds
    v_lshrrev_b32 v8, 5, v0
    v_and_b32 v9, 31, v0
    v_add_u32 v10, 0, v8
    v_xor_b32 v10, v9, v10
    v_lshlrev_b32 v10, 4, v10
    v_lshl_add_u32 v40, v8, 9, v10
    v_add_u32 v10, 2, v8
    v_xor_b32 v10, v9, v10
    v_lshlrev_b32 v10, 4, v10
    v_lshl_add_u32 v41, v8, 9, v10
    v_add_u32 v10, 4, v8
    v_xor_b32 v10, v9, v10
    v_lshlrev_b32 v10, 4, v10
    v_lshl_add_u32 v42, v8, 9, v10
    v_add_u32 v10, 6, v8
    v_xor_b32 v10, v9, v10
    v_lshlrev_b32 v10, 4, v10
    v_lshl_add_u32 v43, v8, 9, v10
    v_lshrrev_b32 v10, 2, v3
    v_and_b32 v11, 3, v3
    v_lshl_add_u32 v12, v8, 3, v10
    s_and_b32 s55, s4, 3
    s_lshl_b32 s55, s55, 2
    v_lshrrev_b32 v13, 1, v11
    v_add_u32 v13, s55, v13
    v_and_b32 v14, 1, v2
    v_lshl_add_u32 v13, v14, 1, v13
    v_lshlrev_b32 v14, 2, v10
    v_xor_b32 v13, v13, v14
    v_lshlrev_b32 v13, 4, v13
    v_lshl_add_u32 v13, v12, 8, v13
    v_and_b32 v14, 1, v11
    v_lshl_add_u32 v13, v14, 3, v13
    s_lshr_b32 s55, s4, 2
    s_lshl_b32 s55, s55, 12
    s_add_u32 s55, s55, 32768
    v_add_u32 v44, s55, v13
    s_waitcnt lgkmcnt(0)
    s_mul_i32 s56, s56, 0x9E3779B1
    s_add_u32 s56, s56, 0x7F4A7C15
    s_barrier
    s_cmp_lg_u32 s4, 3
    s_cbranch_scc1 xid_3
    s_getreg_b32 s55, hwreg(HW_REG_XCC_ID, 0, 4)
    v_mov_b32 v50, s56
    v_mov_b32 v51, s55
    v_lshlrev_b32 v52, 3, v0
    s_lshl_b32 s55, s5, 4
    s_add_u32 s55, s55, s6
    s_lshl_b32 s55, s55, 7
    s_add_u32 s55, s55, 23207936
    s_mov_b64 exec, 0xffff
    buffer_store_dwordx2 v[50:51], v52, s[8:11], s55 offen sc1
    s_mov_b64 exec, -1
xid_3:
    s_cmp_eq_u32 s52, 0
    s_cbranch_scc1 kv0_6
    s_add_u32 m0, s62, 98304
    s_add_u32 s64, s63, 393216
    buffer_load_dwordx4 v5, s[40:43], s64 offen lds
    s_add_u32 m0, s62, 99328
    s_add_u32 s64, s63, 397312
    buffer_load_dwordx4 v5, s[40:43], s64 offen lds
    s_add_u32 m0, s62, 100352
    s_add_u32 s64, s63, 401408
    buffer_load_dwordx4 v5, s[40:43], s64 offen lds
    s_add_u32 m0, s62, 101376
    s_add_u32 s64, s63, 405504
    buffer_load_dwordx4 v5, s[40:43], s64 offen lds
    s_waitcnt vmcnt(12) lgkmcnt(0)
    s_branch kv2_7
kv0_6:
    v_lshlrev_b32 v13, 5, v12
    v_lshl_add_u32 v13, v11, 3, v13
    s_lshl_b32 s55, s4, 11
    v_add_u32 v13, s55, v13
    v_and_b32 v14, 1, v2
    v_mov_b32 v15, 147456
    v_mov_b32 v45, 131072
    v_cmp_eq_u32 vcc, 1, v14
    s_nop 1
    v_cndmask_b32 v15, v15, v45, vcc
    v_add_u32 v13, v13, v15
    s_lshl_b32 s55, s4, 12
    v_add_u32 v46, s55, v40
    v_add_u32 v47, s55, v41
    v_add_u32 v48, s55, v42
    v_add_u32 v49, s55, v43
    ds_read_b64_tr_b16 v[64:65], v13 offset:0
    ds_read_b64_tr_b16 v[66:67], v13 offset:128
    ds_read_b128 v[80:83], v46 offset:0
    ds_read_b64_tr_b16 v[68:69], v13 offset:512
    ds_read_b64_tr_b16 v[70:71], v13 offset:640
    ds_read_b128 v[84:87], v47 offset:1024
    ds_read_b64_tr_b16 v[72:73], v13 offset:1024
    ds_read_b64_tr_b16 v[74:75], v13 offset:1152
    ds_read_b128 v[88:91], v48 offset:2048
    ds_read_b64_tr_b16 v[76:77], v13 offset:1536
    ds_read_b64_tr_b16 v[78:79], v13 offset:1664
    ds_read_b128 v[92:95], v49 offset:3072
    s_waitcnt lgkmcnt(9)
    v_mfma_f32_32x32x16_bf16 v[96:111], v[64:67], v[80:83], 0
    s_waitcnt lgkmcnt(6)
    v_mfma_f32_32x32x16_bf16 v[96:111], v[68:71], v[84:87], v[96:111]
    s_waitcnt lgkmcnt(3)
    v_mfma_f32_32x32x16_bf16 v[96:111], v[72:75], v[88:91], v[96:111]
    s_waitcnt lgkmcnt(0)
    v_mfma_f32_32x32x16_bf16 v[96:111], v[76:79], v[92:95], v[96:111]
    s_lshl_b32 s55, s4, 11
    s_add_u32 s55, s55, 131072
    v_add_u32 v14, s55, v6
    v_add_u32 v15, 16384, v14
    s_nop 10
    ds_write_b128 v14, v[96:99]
    ds_write_b128 v14, v[100:103] offset:1024
    ds_write_b128 v15, v[104:107]
    ds_write_b128 v15, v[108:111] offset:1024
kv1_5:
    s_waitcnt vmcnt(8) lgkmcnt(0)
kv2_7:
    s_barrier
    s_cmp_lg_u32 s52, 0
    s_cbranch_scc1 kvdone_4
    s_cmp_eq_u32 s4, 1
    s_cbranch_scc1 kv_v_8
    s_cmp_lg_u32 s4, 0
    s_cbranch_scc1 kvdone_4
    v_add_u32 v14, 147456, v6
    ds_read_b128 v[64:67], v14 offset:0
    ds_read_b128 v[68:71], v14 offset:1024
    ds_read_b128 v[72:75], v14 offset:2048
    ds_read_b128 v[76:79], v14 offset:3072
    ds_read_b128 v[80:83], v14 offset:4096
    ds_read_b128 v[84:87], v14 offset:5120
    ds_read_b128 v[88:91], v14 offset:6144
    ds_read_b128 v[92:95], v14 offset:7168
    s_waitcnt lgkmcnt(4)
    ds_read_b128 v[96:99], v14 offset:8192
    ds_read_b128 v[100:103], v14 offset:9216
    ds_read_b128 v[104:107], v14 offset:10240
    ds_read_b128 v[108:111], v14 offset:11264
    ds_read_b128 v[112:115], v14 offset:12288
    ds_read_b128 v[116:119], v14 offset:13312
    ds_read_b128 v[120:123], v14 offset:14336
    ds_read_b128 v[124:127], v14 offset:15360
    s_waitcnt lgkmcnt(0)
    v_pk_add_f32 v[64:65], v[64:65], v[72:73]
    v_pk_add_f32 v[66:67], v[66:67], v[74:75]
    v_pk_add_f32 v[68:69], v[68:69], v[76:77]
    v_pk_add_f32 v[70:71], v[70:71], v[78:79]
    v_pk_add_f32 v[64:65], v[64:65], v[80:81]
    v_pk_add_f32 v[66:67], v[66:67], v[82:83]
    v_pk_add_f32 v[68:69], v[68:69], v[84:85]
    v_pk_add_f32 v[70:71], v[70:71], v[86:87]
    v_pk_add_f32 v[64:65], v[64:65], v[88:89]
    v_pk_add_f32 v[66:67], v[66:67], v[90:91]
    v_pk_add_f32 v[68:69], v[68:69], v[92:93]
    v_pk_add_f32 v[70:71], v[70:71], v[94:95]
    v_pk_add_f32 v[64:65], v[64:65], v[96:97]
    v_pk_add_f32 v[66:67], v[66:67], v[98:99]
    v_pk_add_f32 v[68:69], v[68:69], v[100:101]
    v_pk_add_f32 v[70:71], v[70:71], v[102:103]
    v_pk_add_f32 v[64:65], v[64:65], v[104:105]
    v_pk_add_f32 v[66:67], v[66:67], v[106:107]
    v_pk_add_f32 v[68:69], v[68:69], v[108:109]
    v_pk_add_f32 v[70:71], v[70:71], v[110:111]
    v_pk_add_f32 v[64:65], v[64:65], v[112:113]
    v_pk_add_f32 v[66:67], v[66:67], v[114:115]
    v_pk_add_f32 v[68:69], v[68:69], v[116:117]
    v_pk_add_f32 v[70:71], v[70:71], v[118:119]
    v_pk_add_f32 v[64:65], v[64:65], v[120:121]
    v_pk_add_f32 v[66:67], v[66:67], v[122:123]
    v_pk_add_f32 v[68:69], v[68:69], v[124:125]
    v_pk_add_f32 v[70:71], v[70:71], v[126:127]
    v_cvt_pk_bf16_f32 v76, v64, v65
    v_cvt_pk_bf16_f32 v77, v66, v67
    v_cvt_pk_bf16_f32 v78, v68, v69
    v_cvt_pk_bf16_f32 v79, v70, v71
    s_lshl_b32 s55, s7, 10
    s_add_u32 s55, s55, 3145728
    buffer_store_dwordx4 v[76:79], v6, s[8:11], s55 offen sc1
    v_mov_b32 v80, 0
    v_dot2_f32_bf16 v80, v76, v76, v80
    v_dot2_f32_bf16 v80, v77, v77, v80
    v_dot2_f32_bf16 v80, v78, v78, v80
    v_dot2_f32_bf16 v80, v79, v79, v80
    s_nop 2
    v_mov_b32 v81, v80
    s_nop 1
    v_permlane32_swap_b32 v80, v81
    s_nop 1
    v_add_f32 v80, v80, v81
    s_nop 1
    v_max_f32_dpp v80, v80, v80 row_ror:8 row_mask:0xf bank_mask:0xf
    s_nop 1
    v_max_f32_dpp v80, v80, v80 row_ror:4 row_mask:0xf bank_mask:0xf
    s_nop 1
    v_max_f32_dpp v80, v80, v80 row_ror:2 row_mask:0xf bank_mask:0xf
    s_nop 1
    v_max_f32_dpp v80, v80, v80 row_ror:1 row_mask:0xf bank_mask:0xf
    v_mov_b32 v81, v80
    s_nop 1
    v_permlane16_swap_b32 v80, v81
    s_nop 1
    v_max_f32 v80, v80, v81
    v_mov_b32 v253, v80
    s_branch kvdone_4
kv_v_8:
    v_add_u32 v14, 131072, v6
    ds_read_b128 v[64:67], v14 offset:0
    ds_read_b128 v[68:71], v14 offset:1024
    ds_read_b128 v[72:75], v14 offset:2048
    ds_read_b128 v[76:79], v14 offset:3072
    ds_read_b128 v[80:83], v14 offset:4096
    ds_read_b128 v[84:87], v14 offset:5120
    ds_read_b128 v[88:91], v14 offset:6144
    ds_read_b128 v[92:95], v14 offset:7168
    s_waitcnt lgkmcnt(4)
    ds_read_b128 v[96:99], v14 offset:8192
    ds_read_b128 v[100:103], v14 offset:9216
    ds_read_b128 v[104:107], v14 offset:10240
    ds_read_b128 v[108:111], v14 offset:11264
    ds_read_b128 v[112:115], v14 offset:12288
    ds_read_b128 v[116:119], v14 offset:13312
    ds_read_b128 v[120:123], v14 offset:14336
    ds_read_b128 v[124:127], v14 offset:15360
    s_waitcnt lgkmcnt(0)
    v_pk_add_f32 v[64:65], v[64:65], v[72:73]
    v_pk_add_f32 v[66:67], v[66:67], v[74:75]
    v_pk_add_f32 v[68:69], v[68:69], v[76:77]
    v_pk_add_f32 v[70:71], v[70:71], v[78:79]
    v_pk_add_f32 v[64:65], v[64:65], v[80:81]
    v_pk_add_f32 v[66:67], v[66:67], v[82:83]
    v_pk_add_f32 v[68:69], v[68:69], v[84:85]
    v_pk_add_f32 v[70:71], v[70:71], v[86:87]
    v_pk_add_f32 v[64:65], v[64:65], v[88:89]
    v_pk_add_f32 v[66:67], v[66:67], v[90:91]
    v_pk_add_f32 v[68:69], v[68:69], v[92:93]
    v_pk_add_f32 v[70:71], v[70:71], v[94:95]
    v_pk_add_f32 v[64:65], v[64:65], v[96:97]
    v_pk_add_f32 v[66:67], v[66:67], v[98:99]
    v_pk_add_f32 v[68:69], v[68:69], v[100:101]
    v_pk_add_f32 v[70:71], v[70:71], v[102:103]
    v_pk_add_f32 v[64:65], v[64:65], v[104:105]
    v_pk_add_f32 v[66:67], v[66:67], v[106:107]
    v_pk_add_f32 v[68:69], v[68:69], v[108:109]
    v_pk_add_f32 v[70:71], v[70:71], v[110:111]
    v_pk_add_f32 v[64:65], v[64:65], v[112:113]
    v_pk_add_f32 v[66:67], v[66:67], v[114:115]
    v_pk_add_f32 v[68:69], v[68:69], v[116:117]
    v_pk_add_f32 v[70:71], v[70:71], v[118:119]
    v_pk_add_f32 v[64:65], v[64:65], v[120:121]
    v_pk_add_f32 v[66:67], v[66:67], v[122:123]
    v_pk_add_f32 v[68:69], v[68:69], v[124:125]
    v_pk_add_f32 v[70:71], v[70:71], v[126:127]
    v_cvt_pk_bf16_f32 v76, v64, v65
    v_cvt_pk_bf16_f32 v77, v66, v67
    v_cvt_pk_bf16_f32 v78, v68, v69
    v_cvt_pk_bf16_f32 v79, v70, v71
    v_lshlrev_b32 v80, 5, v9
    v_lshl_add_u32 v80, v8, 3, v80
    v_add_u32 v80, 131072, v80
    ds_write_b64 v80, v[76:77]
    ds_write_b64 v80, v[78:79] offset:16
    v_lshl_add_u32 v81, v8, 2, v10
    v_lshlrev_b32 v81, 5, v81
    v_and_b32 v82, 1, v11
    v_lshlrev_b32 v82, 1, v82
    v_lshrrev_b32 v83, 1, v11
    v_add_u32 v82, v82, v83
    v_lshl_add_u32 v81, v82, 3, v81
    v_add_u32 v81, 131072, v81
    s_waitcnt lgkmcnt(0)
    ds_read_b64_tr_b16 v[84:85], v81 offset:0
    ds_read_b64_tr_b16 v[86:87], v81 offset:256
    ds_read_b64_tr_b16 v[88:89], v81 offset:512
    ds_read_b64_tr_b16 v[90:91], v81 offset:768
    v_lshl_add_u32 v82, v8, 4, v3
    v_lshlrev_b32 v82, 4, v82
    s_lshl_b32 s55, s7, 10
    s_add_u32 s55, s55, 3211264
    s_waitcnt lgkmcnt(0)
    s_mov_b32 exec_lo, 0x0000ffff
    s_mov_b32 exec_hi, 0x0000ffff
    buffer_store_dwordx4 v[84:87], v82, s[8:11], s55 offen sc1
    buffer_store_dwordx4 v[88:91], v82, s[8:11], s55 offen offset:512 sc1
    s_mov_b64 exec, -1
kvdone_4:
    v_add_u32 v45, 1024, v44
    s_lshr_b32 s55, s4, 2
    s_cmp_eq_u32 s55, 0
    s_cselect_b64 vcc, -1, 0
    s_lshl_b32 s55, s55, 10
    v_cndmask_b32 v46, v41, v40, vcc
    v_cndmask_b32 v47, v43, v42, vcc
    v_add_u32 v46, s55, v46
    v_add_u32 v47, s55, v47
    ds_read_b64_tr_b16 v[112:113], v44
    ds_read_b64_tr_b16 v[114:115], v45
    ds_read_b128 v[116:119], v46 offset:0
    v_add_u32 v44, 8192, v44
    v_add_u32 v45, 8192, v45
    ds_read_b64_tr_b16 v[120:121], v44
    ds_read_b64_tr_b16 v[122:123], v45
    ds_read_b128 v[124:127], v47 offset:2048
    v_add_u32 v44, 8192, v44
    v_add_u32 v45, 8192, v45
    ds_read_b64_tr_b16 v[128:129], v44
    ds_read_b64_tr_b16 v[130:131], v45
    ds_read_b128 v[132:135], v46 offset:4096
    v_add_u32 v44, 8192, v44
    v_add_u32 v45, 8192, v45
    s_waitcnt lgkmcnt(6)
    v_mfma_f32_32x32x16_bf16 v[96:111], v[112:115], v[116:119], 0
    ds_read_b64_tr_b16 v[112:113], v44
    ds_read_b64_tr_b16 v[114:115], v45
    ds_read_b128 v[116:119], v47 offset:6144
    v_add_u32 v44, 8192, v44
    v_add_u32 v45, 8192, v45
    s_waitcnt lgkmcnt(6)
    v_mfma_f32_32x32x16_bf16 v[96:111], v[120:123], v[124:127], v[96:111]
    s_cmp_eq_u32 s52, 0
    s_cbranch_scc1 qk_9
    s_waitcnt vmcnt(8)
    s_branch qe_10
qk_9:
    s_waitcnt vmcnt(0)
qe_10:
    s_barrier
    s_cmp_lg_u32 s52, 0
    s_cbranch_scc1 noflag_11
    s_cmp_lg_u32 s4, 0
    s_cbranch_scc1 noflag_11
    s_lshl_b32 s55, s7, 7
    s_add_u32 s55, s55, 23134208
    v_lshlrev_b32 v80, 3, v0
    v_mov_b32 v252, s56
    s_mov_b64 exec, 0xffff
    buffer_store_dwordx2 v[252:253], v80, s[8:11], s55 offen sc1
    s_mov_b64 exec, -1
noflag_11:
    s_cmp_lg_u32 s52, 0
    s_cbranch_scc1 q3b_12
    s_add_u32 m0, s62, 98304
    s_add_u32 s64, s63, 393216
    buffer_load_dwordx4 v5, s[40:43], s64 offen lds
    s_add_u32 m0, s62, 99328
    s_add_u32 s64, s63, 397312
    buffer_load_dwordx4 v5, s[40:43], s64 offen lds
    s_add_u32 m0, s62, 100352
    s_add_u32 s64, s63, 401408
    buffer_load_dwordx4 v5, s[40:43], s64 offen lds
    s_add_u32 m0, s62, 101376
    s_add_u32 s64, s63, 405504
    buffer_load_dwordx4 v5, s[40:43], s64 offen lds
q3b_12:
    ds_read_b64_tr_b16 v[120:121], v44
    ds_read_b64_tr_b16 v[122:123], v45
    ds_read_b128 v[124:127], v46 offset:8192
    v_add_u32 v44, 8192, v44
    v_add_u32 v45, 8192, v45
    s_waitcnt lgkmcnt(6)
    v_mfma_f32_32x32x16_bf16 v[96:111], v[128:131], v[132:135], v[96:111]
    ds_read_b64_tr_b16 v[128:129], v44
    ds_read_b64_tr_b16 v[130:131], v45
    ds_read_b128 v[132:135], v47 offset:10240
    v_add_u32 v44, 8192, v44
    v_add_u32 v45, 8192, v45
    s_waitcnt lgkmcnt(6)
    v_mfma_f32_32x32x16_bf16 v[96:111], v[112:115], v[116:119], v[96:111]
    ds_read_b64_tr_b16 v[112:113], v44
    ds_read_b64_tr_b16 v[114:115], v45
    ds_read_b128 v[116:119], v46 offset:12288
    v_add_u32 v44, 8192, v44
    v_add_u32 v45, 8192, v45
    s_waitcnt lgkmcnt(6)
    v_mfma_f32_32x32x16_bf16 v[96:111], v[120:123], v[124:127], v[96:111]
    ds_read_b64_tr_b16 v[120:121], v44
    ds_read_b64_tr_b16 v[122:123], v45
    ds_read_b128 v[124:127], v47 offset:14336
    v_add_u32 v44, 8192, v44
    v_add_u32 v45, 8192, v45
    s_waitcnt lgkmcnt(6)
    v_mfma_f32_32x32x16_bf16 v[96:111], v[128:131], v[132:135], v[96:111]
    s_cmp_eq_u32 s52, 0
    s_cbranch_scc1 qk_13
    s_waitcnt vmcnt(4)
    s_branch qe_14
qk_13:
qe_14:
    s_barrier
    ds_read_b64_tr_b16 v[128:129], v44
    ds_read_b64_tr_b16 v[130:131], v45
    ds_read_b128 v[132:135], v46 offset:16384
    v_add_u32 v44, 8192, v44
    v_add_u32 v45, 8192, v45
    s_waitcnt lgkmcnt(6)
    v_mfma_f32_32x32x16_bf16 v[96:111], v[112:115], v[116:119], v[96:111]
    ds_read_b64_tr_b16 v[112:113], v44
    ds_read_b64_tr_b16 v[114:115], v45
    ds_read_b128 v[116:119], v47 offset:18432
    v_add_u32 v44, 8192, v44
    v_add_u32 v45, 8192, v45
    s_waitcnt lgkmcnt(6)
    v_mfma_f32_32x32x16_bf16 v[96:111], v[120:123], v[124:127], v[96:111]
    ds_read_b64_tr_b16 v[120:121], v44
    ds_read_b64_tr_b16 v[122:123], v45
    ds_read_b128 v[124:127], v46 offset:20480
    v_add_u32 v44, 8192, v44
    v_add_u32 v45, 8192, v45
    s_waitcnt lgkmcnt(6)
    v_mfma_f32_32x32x16_bf16 v[96:111], v[128:131], v[132:135], v[96:111]
    ds_read_b64_tr_b16 v[128:129], v44
    ds_read_b64_tr_b16 v[130:131], v45
    ds_read_b128 v[132:135], v47 offset:22528
    v_add_u32 v44, 8192, v44
    v_add_u32 v45, 8192, v45
    s_waitcnt lgkmcnt(6)
    v_mfma_f32_32x32x16_bf16 v[96:111], v[112:115], v[116:119], v[96:111]
    s_cmp_eq_u32 s52, 0
    s_cbranch_scc1 qk_15
    s_waitcnt vmcnt(0)
    s_branch qe_16
qk_15:
    s_waitcnt vmcnt(0)
qe_16:
    s_barrier
    ds_read_b64_tr_b16 v[112:113], v44
    ds_read_b64_tr_b16 v[114:115], v45
    ds_read_b128 v[116:119], v46 offset:24576
    v_add_u32 v44, 8192, v44
    v_add_u32 v45, 8192, v45
    s_waitcnt lgkmcnt(6)
    v_mfma_f32_32x32x16_bf16 v[96:111], v[120:123], v[124:127], v[96:111]
    ds_read_b64_tr_b16 v[120:121], v44
    ds_read_b64_tr_b16 v[122:123], v45
    ds_read_b128 v[124:127], v47 offset:26624
    v_add_u32 v44, 8192, v44
    v_add_u32 v45, 8192, v45
    s_waitcnt lgkmcnt(6)
    v_mfma_f32_32x32x16_bf16 v[96:111], v[128:131], v[132:135], v[96:111]
    ds_read_b64_tr_b16 v[128:129], v44
    ds_read_b64_tr_b16 v[130:131], v45
    ds_read_b128 v[132:135], v46 offset:28672
    v_add_u32 v44, 8192, v44
    v_add_u32 v45, 8192, v45
    s_waitcnt lgkmcnt(6)
    v_mfma_f32_32x32x16_bf16 v[96:111], v[112:115], v[116:119], v[96:111]
    ds_read_b64_tr_b16 v[112:113], v44
    ds_read_b64_tr_b16 v[114:115], v45
    ds_read_b128 v[116:119], v47 offset:30720
    v_add_u32 v44, 8192, v44
    v_add_u32 v45, 8192, v45
    s_waitcnt lgkmcnt(6)
    v_mfma_f32_32x32x16_bf16 v[96:111], v[120:123], v[124:127], v[96:111]
    s_waitcnt lgkmcnt(3)
    v_mfma_f32_32x32x16_bf16 v[96:111], v[128:131], v[132:135], v[96:111]
    s_waitcnt lgkmcnt(0)
    v_mfma_f32_32x32x16_bf16 v[96:111], v[112:115], v[116:119], v[96:111]
    s_lshl_b32 s55, s4, 12
    s_add_u32 s55, s55, 32768
    v_add_u32 v14, s55, v6
    s_xor_b32 s55, s4, 4
    s_lshl_b32 s55, s55, 12
    s_add_u32 s55, s55, 32768
    v_add_u32 v15, s55, v6
    s_nop 9
    ds_write_b128 v14, v[96:99] offset:0
    ds_write_b128 v14, v[100:103] offset:1024
    ds_write_b128 v14, v[104:107] offset:2048
    ds_write_b128 v14, v[108:111] offset:3072
    s_waitcnt lgkmcnt(0)
    s_barrier
    ds_read_b128 v[64:67], v15 offset:0
    ds_read_b128 v[68:71], v15 offset:1024
    ds_read_b128 v[72:75], v15 offset:2048
    ds_read_b128 v[76:79], v15 offset:3072
    v_mov_b32 v36, 0x3eb8aa3b
    v_mov_b32 v37, v36
    s_waitcnt lgkmcnt(0)
    v_pk_add_f32 v[64:65], v[64:65], v[96:97]
    v_pk_add_f32 v[66:67], v[66:67], v[98:99]
    v_pk_add_f32 v[68:69], v[68:69], v[100:101]
    v_pk_add_f32 v[70:71], v[70:71], v[102:103]
    v_pk_add_f32 v[72:73], v[72:73], v[104:105]
    v_pk_add_f32 v[74:75], v[74:75], v[106:107]
    v_pk_add_f32 v[76:77], v[76:77], v[108:109]
    v_pk_add_f32 v[78:79], v[78:79], v[110:111]
    v_pk_mul_f32 v[64:65], v[64:65], v[36:37]
    v_pk_mul_f32 v[66:67], v[66:67], v[36:37]
    v_pk_mul_f32 v[68:69], v[68:69], v[36:37]
    v_pk_mul_f32 v[70:71], v[70:71], v[36:37]
    v_pk_mul_f32 v[72:73], v[72:73], v[36:37]
    v_pk_mul_f32 v[74:75], v[74:75], v[36:37]
    v_pk_mul_f32 v[76:77], v[76:77], v[36:37]
    v_pk_mul_f32 v[78:79], v[78:79], v[36:37]
    v_cvt_pk_bf16_f32 v244, v64, v65
    v_cvt_pk_bf16_f32 v245, v66, v67
    v_cvt_pk_bf16_f32 v246, v68, v69
    v_cvt_pk_bf16_f32 v247, v70, v71
    v_cvt_pk_bf16_f32 v248, v72, v73
    v_cvt_pk_bf16_f32 v249, v74, v75
    v_cvt_pk_bf16_f32 v250, v76, v77
    v_cvt_pk_bf16_f32 v251, v78, v79
    s_barrier
    v_lshlrev_b32 v1, 4, v0
    s_cmp_lg_u32 s4, 0
    s_cbranch_scc1 sa0_17
    v_lshlrev_b32 v3, 7, v0
    s_mov_b32 s55, 23134208
    buffer_load_dwordx2 v[112:113], v3, s[8:11], s55 offen sc1
sa0_17:
    v_mov_b32 v4, v244
    v_mov_b32 v92, v248
    v_mov_b32 v5, v245
    v_mov_b32 v93, v249
    v_mov_b32 v6, v246
    v_mov_b32 v94, v250
    v_mov_b32 v7, v247
    v_mov_b32 v95, v251
    v_mov_b32 v90, 0
    v_mov_b32 v2, 0
    v_dot2_f32_bf16 v90, v4, v4, v90
    v_dot2_f32_bf16 v2, v92, v92, v2
    v_dot2_f32_bf16 v90, v5, v5, v90
    v_dot2_f32_bf16 v2, v93, v93, v2
    v_dot2_f32_bf16 v90, v6, v6, v90
    v_dot2_f32_bf16 v2, v94, v94, v2
    v_dot2_f32_bf16 v90, v7, v7, v90
    v_dot2_f32_bf16 v2, v95, v95, v2
    s_mov_b32 s70, 0x0000ffff
    s_mov_b32 s71, 0x0000ffff
    s_mov_b32 s62, 0x00110000
    s_mov_b32 s63, s62
    v_mov_b32 v91, 0x3f803f80
    v_cndmask_b32 v72, 0, v91, s[62:63]
    v_cndmask_b32 v73, 0, v91, s[62:63]
    v_cndmask_b32 v74, 0, v91, s[62:63]
    v_cndmask_b32 v75, 0, v91, s[62:63]
    v_cndmask_b32 v76, 0, v91, s[62:63]
    v_cndmask_b32 v77, 0, v91, s[62:63]
    v_cndmask_b32 v78, 0, v91, s[62:63]
    v_cndmask_b32 v79, 0, v91, s[62:63]
    v_cndmask_b32 v80, 0, v91, s[62:63]
    v_cndmask_b32 v81, 0, v91, s[62:63]
    v_cndmask_b32 v82, 0, v91, s[62:63]
    v_cndmask_b32 v83, 0, v91, s[62:63]
    v_cndmask_b32 v84, 0, v91, s[62:63]
    v_cndmask_b32 v85, 0, v91, s[62:63]
    v_cndmask_b32 v86, 0, v91, s[62:63]
    v_cndmask_b32 v87, 0, v91, s[62:63]
    v_mov_b32 v91, v90
    s_nop 1
    v_permlane32_swap_b32 v90, v91
    s_nop 1
    v_add_f32 v90, v90, v91
    v_mov_b32 v91, v2
    s_nop 1
    v_permlane32_swap_b32 v2, v91
    s_nop 1
    v_add_f32 v2, v2, v91
    v_max_f32 v90, v90, v2
    s_nop 1
    v_max_f32_dpp v90, v90, v90 row_ror:8 row_mask:0xf bank_mask:0xf
    s_nop 1
    v_max_f32_dpp v90, v90, v90 row_ror:4 row_mask:0xf bank_mask:0xf
    s_nop 1
    v_max_f32_dpp v90, v90, v90 row_ror:2 row_mask:0xf bank_mask:0xf
    s_nop 1
    v_max_f32_dpp v90, v90, v90 row_ror:1 row_mask:0xf bank_mask:0xf
    v_mov_b32 v91, v90
    s_nop 1
    v_permlane16_swap_b32 v90, v91
    s_nop 1
    v_max_f32 v90, v90, v91
    s_lshl_b32 s61, s4, 2
    s_add_u32 s61, s61, 135104
    v_mov_b32 v91, s61
    s_mov_b64 exec, 1
    ds_write_b32 v91, v90
    s_mov_b64 exec, -1
    s_lshr_b32 s61, s4, 2
    s_lshl_b32 s61, s61, 15
    v_add_u32 v88, s61, v1
    v_lshrrev_b32 v90, 5, v0
    v_and_b32 v91, 15, v0
    v_lshl_add_u32 v90, v90, 4, v91
    v_lshlrev_b32 v90, 4, v90
    s_add_u32 s61, s61, 65536
    v_add_u32 v89, s61, v90
    s_lshl_b32 s68, s52, 3
    s_add_u32 s68, s68, s4
    s_lshl_b32 s68, s68, 14
    s_add_u32 s68, s68, 3670016
    s_min_u32 s73, s4, 6
    s_mul_i32 s74, s6, 7
    s_add_u32 s74, s74, s73
    s_lshl_b32 s73, s74, 15
    s_add_u32 s73, s73, 9437184
    s_lshr_b32 s54, s4, 2
    s_lshl_b32 s54, s54, 4
    s_and_b32 s61, s4, 3
    s_add_u32 s54, s54, s61
    s_lshl_b32 s54, s54, 11
    s_cmp_lg_u32 s4, 0
    s_cbranch_scc1 sa_18
    s_waitcnt vmcnt(0)
    v_cmp_ne_u32 vcc, s56, v112
    s_nop 4
    s_cbranch_vccz syncA_19
    s_mov_b32 s79, 400000
pollA_20:
    buffer_load_dwordx2 v[112:113], v3, s[8:11], s55 offen sc1
    s_waitcnt vmcnt(0)
    v_cmp_ne_u32 vcc, s56, v112
    s_nop 4
    s_cbranch_vccz syncA_19
    s_sleep 2
    s_sub_u32 s79, s79, 1
    s_cmp_lg_u32 s79, 0
    s_cbranch_scc1 pollA_20
syncA_19:
    s_nop 1
    v_max_f32_dpp v113, v113, v113 row_ror:8 row_mask:0xf bank_mask:0xf
    s_nop 1
    v_max_f32_dpp v113, v113, v113 row_ror:4 row_mask:0xf bank_mask:0xf
    s_nop 1
    v_max_f32_dpp v113, v113, v113 row_ror:2 row_mask:0xf bank_mask:0xf
    s_nop 1
    v_max_f32_dpp v113, v113, v113 row_ror:1 row_mask:0xf bank_mask:0xf
    v_mov_b32 v91, v113
    s_nop 1
    v_permlane16_swap_b32 v113, v91
    s_nop 1
    v_max_f32 v113, v113, v91
    v_mov_b32 v91, v113
    s_nop 1
    v_permlane32_swap_b32 v113, v91
    s_nop 1
    v_max_f32 v113, v113, v91
    v_mov_b32 v91, 135040
    s_mov_b64 exec, 1
    ds_write_b32 v91, v113
    s_mov_b64 exec, -1
sa_18:
    s_waitcnt lgkmcnt(0)
    s_barrier
    s_add_u32 m0, s54, 0
    s_add_u32 s62, s54, 3145728
    buffer_load_dwordx4 v1, s[8:11], s62 offen sc1 lds
    buffer_load_dwordx4 v1, s[8:11], s62 offen offset:1024 sc1 lds
    s_add_u32 m0, s54, 65536
    s_add_u32 s62, s54, 3211264
    buffer_load_dwordx4 v1, s[8:11], s62 offen sc1 lds
    buffer_load_dwordx4 v1, s[8:11], s62 offen offset:1024 sc1 lds
    v_mov_b32 v91, 135040
    ds_read_b32 v3, v91
    ds_read_b128 v[112:115], v91 offset:64
    ds_read_b128 v[116:119], v91 offset:80
    s_waitcnt lgkmcnt(0)
    v_max3_f32 v112, v112, v113, v114
    v_max3_f32 v116, v116, v117, v118
    v_max3_f32 v112, v112, v115, v119
    v_max_f32 v112, v112, v116
    v_mul_f32 v90, v112, v3
    v_mov_b32 v91, 0x44c80000
    v_cmp_gt_f32 vcc, v90, v91
    s_waitcnt vmcnt(0)
    s_cmp_lg_u64 vcc, 0
    s_cselect_b32 s61, 1, 0
    s_barrier
    ds_read_b128 v[64:67], v88
    ds_read_b128 v[68:71], v88 offset:1024
    s_mov_b64 exec, s[70:71]
    ds_read_b128 v[72:75], v89
    ds_read_b128 v[80:83], v89 offset:512
    s_mov_b64 exec, -1
    s_waitcnt lgkmcnt(0)
    s_cmp_lg_u32 s61, 0
    s_cbranch_scc1 slow_21
    v_mfma_f32_32x32x16_bf16 v[24:39], v[64:67], v[4:7], 0
    s_nop 15
    s_waitcnt lgkmcnt(0)
    v_mfma_f32_32x32x16_bf16 v[40:55], v[64:67], v[92:95], 0
    v_exp_f32 v24, v24
    v_exp_f32 v25, v25
    v_exp_f32 v26, v26
    v_exp_f32 v27, v27
    v_cvt_pk_bf16_f32 v56, v24, v25
    s_mov_b64 exec, s[70:71]
    ds_read_b128 v[76:79], v89 offset:1024
    ds_read_b128 v[84:87], v89 offset:1536
    s_mov_b64 exec, -1
    s_add_u32 m0, s54, 8192
    s_add_u32 s62, s54, 3153920
    buffer_load_dwordx4 v1, s[8:11], s62 offen sc1 lds
    buffer_load_dwordx4 v1, s[8:11], s62 offen offset:1024 sc1 lds
    v_exp_f32 v28, v28
    v_cvt_pk_bf16_f32 v57, v26, v27
    v_exp_f32 v29, v29
    v_exp_f32 v30, v30
    v_exp_f32 v31, v31
    v_cvt_pk_bf16_f32 v58, v28, v29
    v_exp_f32 v32, v32
    v_cvt_pk_bf16_f32 v59, v30, v31
    v_exp_f32 v33, v33
    v_exp_f32 v34, v34
    v_exp_f32 v35, v35
    v_mfma_f32_32x32x16_bf16 v[8:23], v[72:75], v[56:59], 0
    v_cvt_pk_bf16_f32 v60, v32, v33
    v_exp_f32 v36, v36
    v_cvt_pk_bf16_f32 v61, v34, v35
    v_exp_f32 v37, v37
    v_exp_f32 v38, v38
    v_exp_f32 v39, v39
    v_cvt_pk_bf16_f32 v62, v36, v37
    v_cvt_pk_bf16_f32 v63, v38, v39
    s_waitcnt lgkmcnt(0)
    v_mfma_f32_32x32x16_bf16 v[24:39], v[68:71], v[4:7], 0
    ds_read_b128 v[64:67], v88 offset:2048
    v_exp_f32 v40, v40
    v_exp_f32 v41, v41
    v_exp_f32 v42, v42
    v_exp_f32 v43, v43
    v_cvt_pk_bf16_f32 v56, v40, v41
    v_mfma_f32_32x32x16_bf16 v[8:23], v[80:83], v[60:63], v[8:23]
    s_add_u32 m0, s54, 73728
    s_add_u32 s62, s54, 3219456
    buffer_load_dwordx4 v1, s[8:11], s62 offen sc1 lds
    buffer_load_dwordx4 v1, s[8:11], s62 offen offset:1024 sc1 lds
    v_lshrrev_b32 v143, 4, v0
    v_and_b32 v144, 15, v0
    v_lshrrev_b32 v145, 5, v0
    v_lshrrev_b32 v146, 2, v144
    v_and_b32 v147, 3, v144
    v_and_b32 v148, 1, v147
    v_lshlrev_b32 v148, 1, v148
    v_lshrrev_b32 v149, 1, v147
    v_add_u32 v148, v148, v149
    v_lshlrev_b32 v148, 3, v148
    v_and_b32 v149, 1, v143
    v_lshl_add_u32 v150, v145, 3, v146
    s_lshl_b32 s57, s4, 12
    s_add_u32 s57, s57, 131072
    s_mov_b32 s78, 0
    s_cmp_ge_u32 s2, 112
    s_cbranch_scc1 wjo_23
    s_mov_b32 s78, 1
    s_lshr_b32 s60, s2, 2
    s_and_b32 s61, s2, 3
    s_lshl_b32 s62, s61, 3
    s_add_u32 s62, s62, s4
    s_mov_b32 s20, s28
    s_mov_b32 s21, s29
    s_mov_b32 s22, 0x1c0000
    s_mov_b32 s23, 0x00020000
    s_mov_b32 s36, s30
    s_mov_b32 s37, s31
    s_mov_b32 s38, 0x1c0000
    s_mov_b32 s39, 0x00020000
    v_lshrrev_b32 v151, 3, v0
    s_mov_b32 s63, 3584
    v_mul_lo_u32 v151, v151, s63
    v_and_b32 v152, 7, v0
    v_lshl_add_u32 v140, v152, 4, v151
    s_mul_i32 s58, s62, 57344
    s_lshl_b32 s63, s60, 7
    s_add_u32 s58, s58, s63
    v_lshlrev_b32 v151, 7, v150
    v_lshl_add_u32 v151, v149, 11, v151
    v_add_u32 v151, v151, v148
    v_add_u32 v141, s57, v151
    s_lshl_b32 s59, s60, 7
    s_add_u32 s59, s59, s62
    s_lshl_b32 s59, s59, 10
    s_add_u32 s59, s59, 9437184
    s_mul_i32 s72, s61, 112
    s_lshl_b32 s63, s60, 2
    s_add_u32 s72, s72, s63
    s_lshl_b32 s72, s72, 7
    s_add_u32 s72, s72, 3407872
    v_lshlrev_b32 v151, 2, v0
    v_add_u32 v142, s57, v151
    s_branch wjd_24
wjo_23:
    s_cmp_ge_u32 s2, 184
    s_cbranch_scc1 wjd_24
    s_sub_u32 s60, s2, 112
    s_lshl_b32 s60, s60, 3
    s_add_u32 s60, s60, s4
    s_cmp_ge_u32 s60, 128
    s_cbranch_scc1 wjwd_25
    s_mov_b32 s78, 3
    s_mov_b32 s20, s24
    s_mov_b32 s21, s25
    s_mov_b32 s22, 0x80000
    s_mov_b32 s23, 0x00020000
    s_lshr_b32 s61, s60, 3
    s_and_b32 s62, s60, 7
    v_lshrrev_b32 v151, 3, v0
    v_lshlrev_b32 v151, 10, v151
    v_and_b32 v152, 7, v0
    v_lshl_add_u32 v140, v152, 4, v151
    s_lshl_b32 s58, s61, 15
    s_lshl_b32 s60, s62, 7
    s_add_u32 s58, s58, s60
    s_mov_b32 s69, 8192
    v_lshl_add_u32 v151, v143, 3, v146
    v_lshlrev_b32 v151, 7, v151
    v_lshl_add_u32 v151, v147, 3, v151
    v_add_u32 v141, s57, v151
    s_lshl_b32 s59, s62, 6
    s_add_u32 s59, s59, s61
    s_lshl_b32 s59, s59, 10
    s_add_u32 s59, s59, 3670016
    s_mov_b32 s72, 16384
    s_branch wjd_24
wjwd_25:
    s_mov_b32 s78, 2
    s_sub_u32 s60, s60, 128
    s_mov_b32 s20, s32
    s_mov_b32 s21, s33
    s_mov_b32 s22, 0x1c0000
    s_mov_b32 s23, 0x00020000
    s_lshr_b32 s61, s60, 2
    s_and_b32 s62, s60, 3
    v_lshlrev_b32 v151, 10, v143
    v_lshl_add_u32 v140, v144, 4, v151
    s_lshl_b32 s58, s61, 14
    s_lshl_b32 s60, s62, 8
    s_add_u32 s58, s58, s60
    s_mov_b32 s69, 4096
    v_lshlrev_b32 v151, 8, v150
    v_lshl_add_u32 v151, v149, 5, v151
    v_add_u32 v151, v151, v148
    v_add_u32 v141, s57, v151
    s_lshl_b32 s59, s62, 2
    s_mul_i32 s59, s59, 112
    s_add_u32 s59, s59, s61
    s_lshl_b32 s59, s59, 10
    s_add_u32 s59, s59, 7405568
    s_mov_b32 s72, 114688
wjd_24:
    v_exp_f32 v44, v44
    v_cvt_pk_bf16_f32 v57, v42, v43
    v_exp_f32 v45, v45
    v_exp_f32 v46, v46
    v_exp_f32 v47, v47
    v_cvt_pk_bf16_f32 v58, v44, v45
    v_exp_f32 v48, v48
    v_cvt_pk_bf16_f32 v59, v46, v47
    v_exp_f32 v49, v49
    v_exp_f32 v50, v50
    v_exp_f32 v51, v51
    v_mfma_f32_32x32x16_bf16 v[96:111], v[72:75], v[56:59], 0
    v_cvt_pk_bf16_f32 v60, v48, v49
    v_exp_f32 v52, v52
    v_cvt_pk_bf16_f32 v61, v50, v51
    v_exp_f32 v53, v53
    v_exp_f32 v54, v54
    v_exp_f32 v55, v55
    v_cvt_pk_bf16_f32 v62, v52, v53
    v_cvt_pk_bf16_f32 v63, v54, v55
    s_waitcnt lgkmcnt(0)
    v_mfma_f32_32x32x16_bf16 v[40:55], v[68:71], v[92:95], 0
    v_exp_f32 v24, v24
    v_exp_f32 v25, v25
    v_exp_f32 v26, v26
    v_exp_f32 v27, v27
    v_cvt_pk_bf16_f32 v56, v24, v25
    v_mfma_f32_32x32x16_bf16 v[96:111], v[80:83], v[60:63], v[96:111]
    s_mov_b64 exec, s[70:71]
    ds_read_b128 v[72:75], v89 offset:2048
    ds_read_b128 v[80:83], v89 offset:2560
    s_mov_b64 exec, -1
    s_cmp_eq_u32 s78, 1
    s_cbranch_scc0 jo_26
    s_add_u32 m0, s57, 0
    s_add_u32 s63, s58, 0
    buffer_load_dwordx4 v140, s[20:23], s63 offen lds
    s_add_u32 m0, s57, 2048
    s_nop 0
    buffer_load_dwordx4 v140, s[36:39], s63 offen lds
    s_branch je_27
jo_26:
    s_cmp_eq_u32 s78, 0
    s_cbranch_scc1 je_27
    s_add_u32 m0, s57, 0
    s_mul_i32 s63, s69, 0
    s_add_u32 s63, s63, s58
    buffer_load_dwordx4 v140, s[20:23], s63 offen lds
    s_add_u32 m0, s57, 1024
    s_mul_i32 s63, s69, 1
    s_add_u32 s63, s63, s58
    buffer_load_dwordx4 v140, s[20:23], s63 offen lds
je_27:
    v_exp_f32 v28, v28
    v_cvt_pk_bf16_f32 v57, v26, v27
    v_exp_f32 v29, v29
    v_exp_f32 v30, v30
    v_exp_f32 v31, v31
    v_cvt_pk_bf16_f32 v58, v28, v29
    v_exp_f32 v32, v32
    v_cvt_pk_bf16_f32 v59, v30, v31
    v_exp_f32 v33, v33
    v_exp_f32 v34, v34
    v_exp_f32 v35, v35
    v_mfma_f32_32x32x16_bf16 v[8:23], v[76:79], v[56:59], v[8:23]
    v_cvt_pk_bf16_f32 v60, v32, v33
    v_exp_f32 v36, v36
    v_cvt_pk_bf16_f32 v61, v34, v35
    v_exp_f32 v37, v37
    v_exp_f32 v38, v38
    v_exp_f32 v39, v39
    v_cvt_pk_bf16_f32 v62, v36, v37
    v_cvt_pk_bf16_f32 v63, v38, v39
    s_waitcnt lgkmcnt(0)
    v_mfma_f32_32x32x16_bf16 v[24:39], v[64:67], v[4:7], 0
    ds_read_b128 v[68:71], v88 offset:3072
    v_exp_f32 v40, v40
    v_exp_f32 v41, v41
    v_exp_f32 v42, v42
    v_exp_f32 v43, v43
    v_cvt_pk_bf16_f32 v56, v40, v41
    v_mfma_f32_32x32x16_bf16 v[8:23], v[84:87], v[60:63], v[8:23]
    s_cmp_eq_u32 s78, 1
    s_cbranch_scc0 jo_28
    s_add_u32 m0, s57, 1024
    s_add_u32 s63, s58, 28672
    buffer_load_dwordx4 v140, s[20:23], s63 offen lds
    s_add_u32 m0, s57, 3072
    s_nop 0
    buffer_load_dwordx4 v140, s[36:39], s63 offen lds
    s_branch je_29
jo_28:
    s_cmp_eq_u32 s78, 0
    s_cbranch_scc1 je_29
    s_add_u32 m0, s57, 2048
    s_mul_i32 s63, s69, 2
    s_add_u32 s63, s63, s58
    buffer_load_dwordx4 v140, s[20:23], s63 offen lds
    s_add_u32 m0, s57, 3072
    s_mul_i32 s63, s69, 3
    s_add_u32 s63, s63, s58
    buffer_load_dwordx4 v140, s[20:23], s63 offen lds
je_29:
    v_exp_f32 v44, v44
    v_cvt_pk_bf16_f32 v57, v42, v43
    v_exp_f32 v45, v45
    v_exp_f32 v46, v46
    v_exp_f32 v47, v47
    v_cvt_pk_bf16_f32 v58, v44, v45
    v_exp_f32 v48, v48
    v_cvt_pk_bf16_f32 v59, v46, v47
    v_exp_f32 v49, v49
    v_exp_f32 v50, v50
    v_exp_f32 v51, v51
    v_mfma_f32_32x32x16_bf16 v[96:111], v[76:79], v[56:59], v[96:111]
    v_cvt_pk_bf16_f32 v60, v48, v49
    v_exp_f32 v52, v52
    v_cvt_pk_bf16_f32 v61, v50, v51
    v_exp_f32 v53, v53
    v_exp_f32 v54, v54
    v_exp_f32 v55, v55
    v_cvt_pk_bf16_f32 v62, v52, v53
    v_cvt_pk_bf16_f32 v63, v54, v55
    s_waitcnt lgkmcnt(0)
    v_mfma_f32_32x32x16_bf16 v[40:55], v[64:67], v[92:95], 0
    v_exp_f32 v24, v24
    v_exp_f32 v25, v25
    v_exp_f32 v26, v26
    v_exp_f32 v27, v27
    v_cvt_pk_bf16_f32 v56, v24, v25
    v_mfma_f32_32x32x16_bf16 v[96:111], v[84:87], v[60:63], v[96:111]
    s_mov_b64 exec, s[70:71]
    ds_read_b128 v[76:79], v89 offset:3072
    ds_read_b128 v[84:87], v89 offset:3584
    s_mov_b64 exec, -1
    s_add_u32 m0, s54, 16384
    s_add_u32 s62, s54, 3162112
    buffer_load_dwordx4 v1, s[8:11], s62 offen sc1 lds
    buffer_load_dwordx4 v1, s[8:11], s62 offen offset:1024 sc1 lds
    v_exp_f32 v28, v28
    v_cvt_pk_bf16_f32 v57, v26, v27
    v_exp_f32 v29, v29
    v_exp_f32 v30, v30
    v_exp_f32 v31, v31
    v_cvt_pk_bf16_f32 v58, v28, v29
    v_exp_f32 v32, v32
    v_cvt_pk_bf16_f32 v59, v30, v31
    v_exp_f32 v33, v33
    v_exp_f32 v34, v34
    v_exp_f32 v35, v35
    v_mfma_f32_32x32x16_bf16 v[8:23], v[72:75], v[56:59], v[8:23]
    v_cvt_pk_bf16_f32 v60, v32, v33
    v_exp_f32 v36, v36
    v_cvt_pk_bf16_f32 v61, v34, v35
    v_exp_f32 v37, v37
    v_exp_f32 v38, v38
    v_exp_f32 v39, v39
    v_cvt_pk_bf16_f32 v62, v36, v37
    v_cvt_pk_bf16_f32 v63, v38, v39
    s_waitcnt lgkmcnt(0)
    v_mfma_f32_32x32x16_bf16 v[24:39], v[68:71], v[4:7], 0
    ds_read_b128 v[64:67], v88 offset:4096
    v_exp_f32 v40, v40
    v_exp_f32 v41, v41
    v_exp_f32 v42, v42
    v_exp_f32 v43, v43
    v_cvt_pk_bf16_f32 v56, v40, v41
    v_mfma_f32_32x32x16_bf16 v[8:23], v[80:83], v[60:63], v[8:23]
    s_add_u32 m0, s54, 81920
    s_add_u32 s62, s54, 3227648
    buffer_load_dwordx4 v1, s[8:11], s62 offen sc1 lds
    buffer_load_dwordx4 v1, s[8:11], s62 offen offset:1024 sc1 lds
    v_exp_f32 v44, v44
    v_cvt_pk_bf16_f32 v57, v42, v43
    v_exp_f32 v45, v45
    v_exp_f32 v46, v46
    v_exp_f32 v47, v47
    v_cvt_pk_bf16_f32 v58, v44, v45
    v_exp_f32 v48, v48
    v_cvt_pk_bf16_f32 v59, v46, v47
    v_exp_f32 v49, v49
    v_exp_f32 v50, v50
    v_exp_f32 v51, v51
    v_mfma_f32_32x32x16_bf16 v[96:111], v[72:75], v[56:59], v[96:111]
    v_cvt_pk_bf16_f32 v60, v48, v49
    v_exp_f32 v52, v52
    v_cvt_pk_bf16_f32 v61, v50, v51
    v_exp_f32 v53, v53
    v_exp_f32 v54, v54
    v_exp_f32 v55, v55
    v_cvt_pk_bf16_f32 v62, v52, v53
    v_cvt_pk_bf16_f32 v63, v54, v55
    s_waitcnt lgkmcnt(0)
    v_mfma_f32_32x32x16_bf16 v[40:55], v[68:71], v[92:95], 0
    v_exp_f32 v24, v24
    v_exp_f32 v25, v25
    v_exp_f32 v26, v26
    v_exp_f32 v27, v27
    v_cvt_pk_bf16_f32 v56, v24, v25
    v_mfma_f32_32x32x16_bf16 v[96:111], v[80:83], v[60:63], v[96:111]
    s_mov_b64 exec, s[70:71]
    ds_read_b128 v[72:75], v89 offset:4096
    ds_read_b128 v[80:83], v89 offset:4608
    s_mov_b64 exec, -1
    s_add_u32 m0, s54, 24576
    s_add_u32 s62, s54, 3170304
    buffer_load_dwordx4 v1, s[8:11], s62 offen sc1 lds
    buffer_load_dwordx4 v1, s[8:11], s62 offen offset:1024 sc1 lds
    v_exp_f32 v28, v28
    v_cvt_pk_bf16_f32 v57, v26, v27
    v_exp_f32 v29, v29
    v_exp_f32 v30, v30
    v_exp_f32 v31, v31
    v_cvt_pk_bf16_f32 v58, v28, v29
    v_exp_f32 v32, v32
    v_cvt_pk_bf16_f32 v59, v30, v31
    v_exp_f32 v33, v33
    v_exp_f32 v34, v34
    v_exp_f32 v35, v35
    v_mfma_f32_32x32x16_bf16 v[8:23], v[76:79], v[56:59], v[8:23]
    v_cvt_pk_bf16_f32 v60, v32, v33
    v_exp_f32 v36, v36
    v_cvt_pk_bf16_f32 v61, v34, v35
    v_exp_f32 v37, v37
    v_exp_f32 v38, v38
    v_exp_f32 v39, v39
    v_cvt_pk_bf16_f32 v62, v36, v37
    v_cvt_pk_bf16_f32 v63, v38, v39
    s_waitcnt lgkmcnt(0)
    v_mfma_f32_32x32x16_bf16 v[24:39], v[64:67], v[4:7], 0
    ds_read_b128 v[68:71], v88 offset:5120
    v_exp_f32 v40, v40
    v_exp_f32 v41, v41
    v_exp_f32 v42, v42
    v_exp_f32 v43, v43
    v_cvt_pk_bf16_f32 v56, v40, v41
    v_mfma_f32_32x32x16_bf16 v[8:23], v[84:87], v[60:63], v[8:23]
    s_add_u32 m0, s54, 90112
    s_add_u32 s62, s54, 3235840
    buffer_load_dwordx4 v1, s[8:11], s62 offen sc1 lds
    buffer_load_dwordx4 v1, s[8:11], s62 offen offset:1024 sc1 lds
    v_exp_f32 v44, v44
    v_cvt_pk_bf16_f32 v57, v42, v43
    v_exp_f32 v45, v45
    v_exp_f32 v46, v46
    v_exp_f32 v47, v47
    v_cvt_pk_bf16_f32 v58, v44, v45
    v_exp_f32 v48, v48
    v_cvt_pk_bf16_f32 v59, v46, v47
    v_exp_f32 v49, v49
    v_exp_f32 v50, v50
    v_exp_f32 v51, v51
    v_mfma_f32_32x32x16_bf16 v[96:111], v[76:79], v[56:59], v[96:111]
    v_cvt_pk_bf16_f32 v60, v48, v49
    v_exp_f32 v52, v52
    v_cvt_pk_bf16_f32 v61, v50, v51
    v_exp_f32 v53, v53
    v_exp_f32 v54, v54
    v_exp_f32 v55, v55
    v_cvt_pk_bf16_f32 v62, v52, v53
    v_cvt_pk_bf16_f32 v63, v54, v55
    s_barrier
    s_waitcnt lgkmcnt(0)
    v_mfma_f32_32x32x16_bf16 v[40:55], v[64:67], v[92:95], 0
    v_exp_f32 v24, v24
    v_exp_f32 v25, v25
    v_exp_f32 v26, v26
    v_exp_f32 v27, v27
    v_cvt_pk_bf16_f32 v56, v24, v25
    v_mfma_f32_32x32x16_bf16 v[96:111], v[84:87], v[60:63], v[96:111]
    s_mov_b64 exec, s[70:71]
    ds_read_b128 v[76:79], v89 offset:5120
    ds_read_b128 v[84:87], v89 offset:5632
    s_mov_b64 exec, -1
    v_exp_f32 v28, v28
    v_cvt_pk_bf16_f32 v57, v26, v27
    v_exp_f32 v29, v29
    v_exp_f32 v30, v30
    v_exp_f32 v31, v31
    v_cvt_pk_bf16_f32 v58, v28, v29
    v_exp_f32 v32, v32
    v_cvt_pk_bf16_f32 v59, v30, v31
    v_exp_f32 v33, v33
    v_exp_f32 v34, v34
    v_exp_f32 v35, v35
    v_mfma_f32_32x32x16_bf16 v[8:23], v[72:75], v[56:59], v[8:23]
    v_cvt_pk_bf16_f32 v60, v32, v33
    v_exp_f32 v36, v36
    v_cvt_pk_bf16_f32 v61, v34, v35
    v_exp_f32 v37, v37
    v_exp_f32 v38, v38
    v_exp_f32 v39, v39
    v_cvt_pk_bf16_f32 v62, v36, v37
    v_cvt_pk_bf16_f32 v63, v38, v39
    s_waitcnt lgkmcnt(0)
    v_mfma_f32_32x32x16_bf16 v[24:39], v[68:71], v[4:7], 0
    ds_read_b128 v[64:67], v88 offset:6144
    v_exp_f32 v40, v40
    v_exp_f32 v41, v41
    v_exp_f32 v42, v42
    v_exp_f32 v43, v43
    v_cvt_pk_bf16_f32 v56, v40, v41
    v_mfma_f32_32x32x16_bf16 v[8:23], v[80:83], v[60:63], v[8:23]
    v_exp_f32 v44, v44
    v_cvt_pk_bf16_f32 v57, v42, v43
    v_exp_f32 v45, v45
    v_exp_f32 v46, v46
    v_exp_f32 v47, v47
    v_cvt_pk_bf16_f32 v58, v44, v45
    v_exp_f32 v48, v48
    v_cvt_pk_bf16_f32 v59, v46, v47
    v_exp_f32 v49, v49
    v_exp_f32 v50, v50
    v_exp_f32 v51, v51
    v_mfma_f32_32x32x16_bf16 v[96:111], v[72:75], v[56:59], v[96:111]
    v_cvt_pk_bf16_f32 v60, v48, v49
    v_exp_f32 v52, v52
    v_cvt_pk_bf16_f32 v61, v50, v51
    v_exp_f32 v53, v53
    v_exp_f32 v54, v54
    v_exp_f32 v55, v55
    v_cvt_pk_bf16_f32 v62, v52, v53
    v_cvt_pk_bf16_f32 v63, v54, v55
    s_waitcnt lgkmcnt(0)
    v_mfma_f32_32x32x16_bf16 v[40:55], v[68:71], v[92:95], 0
    v_exp_f32 v24, v24
    v_exp_f32 v25, v25
    v_exp_f32 v26, v26
    v_exp_f32 v27, v27
    v_cvt_pk_bf16_f32 v56, v24, v25
    v_mfma_f32_32x32x16_bf16 v[96:111], v[80:83], v[60:63], v[96:111]
    s_mov_b64 exec, s[70:71]
    ds_read_b128 v[72:75], v89 offset:6144
    ds_read_b128 v[80:83], v89 offset:6656
    s_mov_b64 exec, -1
    v_exp_f32 v28, v28
    v_cvt_pk_bf16_f32 v57, v26, v27
    v_exp_f32 v29, v29
    v_exp_f32 v30, v30
    v_exp_f32 v31, v31
    v_cvt_pk_bf16_f32 v58, v28, v29
    v_exp_f32 v32, v32
    v_cvt_pk_bf16_f32 v59, v30, v31
    v_exp_f32 v33, v33
    v_exp_f32 v34, v34
    v_exp_f32 v35, v35
    v_mfma_f32_32x32x16_bf16 v[8:23], v[76:79], v[56:59], v[8:23]
    v_cvt_pk_bf16_f32 v60, v32, v33
    v_exp_f32 v36, v36
    v_cvt_pk_bf16_f32 v61, v34, v35
    v_exp_f32 v37, v37
    v_exp_f32 v38, v38
    v_exp_f32 v39, v39
    v_cvt_pk_bf16_f32 v62, v36, v37
    v_cvt_pk_bf16_f32 v63, v38, v39
    s_waitcnt lgkmcnt(0)
    v_mfma_f32_32x32x16_bf16 v[24:39], v[64:67], v[4:7], 0
    ds_read_b128 v[68:71], v88 offset:7168
    v_exp_f32 v40, v40
    v_exp_f32 v41, v41
    v_exp_f32 v42, v42
    v_exp_f32 v43, v43
    v_cvt_pk_bf16_f32 v56, v40, v41
    v_mfma_f32_32x32x16_bf16 v[8:23], v[84:87], v[60:63], v[8:23]
    v_exp_f32 v44, v44
    v_cvt_pk_bf16_f32 v57, v42, v43
    v_exp_f32 v45, v45
    v_exp_f32 v46, v46
    v_exp_f32 v47, v47
    v_cvt_pk_bf16_f32 v58, v44, v45
    v_exp_f32 v48, v48
    v_cvt_pk_bf16_f32 v59, v46, v47
    v_exp_f32 v49, v49
    v_exp_f32 v50, v50
    v_exp_f32 v51, v51
    v_mfma_f32_32x32x16_bf16 v[96:111], v[76:79], v[56:59], v[96:111]
    v_cvt_pk_bf16_f32 v60, v48, v49
    v_exp_f32 v52, v52
    v_cvt_pk_bf16_f32 v61, v50, v51
    v_exp_f32 v53, v53
    v_exp_f32 v54, v54
    v_exp_f32 v55, v55
    v_cvt_pk_bf16_f32 v62, v52, v53
    v_cvt_pk_bf16_f32 v63, v54, v55
    s_waitcnt vmcnt(8)
    s_barrier
    s_waitcnt lgkmcnt(0)
    v_mfma_f32_32x32x16_bf16 v[40:55], v[64:67], v[92:95], 0
    v_exp_f32 v24, v24
    v_exp_f32 v25, v25
    v_exp_f32 v26, v26
    v_exp_f32 v27, v27
    v_cvt_pk_bf16_f32 v56, v24, v25
    v_mfma_f32_32x32x16_bf16 v[96:111], v[84:87], v[60:63], v[96:111]
    s_mov_b64 exec, s[70:71]
    ds_read_b128 v[76:79], v89 offset:7168
    ds_read_b128 v[84:87], v89 offset:7680
    s_mov_b64 exec, -1
    s_cmp_eq_u32 s78, 0
    s_cbranch_scc1 jre_31
    s_cmp_eq_u32 s78, 2
    s_cbranch_scc1 jr2_30
    s_waitcnt vmcnt(8)
    ds_read_b64_tr_b16 v[112:113], v141 offset:0
    ds_read_b64_tr_b16 v[114:115], v141 offset:512
    ds_read_b64_tr_b16 v[116:117], v141 offset:32
    ds_read_b64_tr_b16 v[118:119], v141 offset:544
    ds_read_b64_tr_b16 v[120:121], v141 offset:64
    ds_read_b64_tr_b16 v[122:123], v141 offset:576
    ds_read_b64_tr_b16 v[124:125], v141 offset:96
    ds_read_b64_tr_b16 v[126:127], v141 offset:608
    s_branch jre_31
jr2_30:
    s_waitcnt vmcnt(8)
    ds_read_b64_tr_b16 v[112:113], v141 offset:0
    ds_read_b64_tr_b16 v[114:115], v141 offset:1024
    ds_read_b64_tr_b16 v[116:117], v141 offset:64
    ds_read_b64_tr_b16 v[118:119], v141 offset:1088
    ds_read_b64_tr_b16 v[120:121], v141 offset:128
    ds_read_b64_tr_b16 v[122:123], v141 offset:1152
    ds_read_b64_tr_b16 v[124:125], v141 offset:192
    ds_read_b64_tr_b16 v[126:127], v141 offset:1216
jre_31:
    v_exp_f32 v28, v28
    v_cvt_pk_bf16_f32 v57, v26, v27
    v_exp_f32 v29, v29
    v_exp_f32 v30, v30
    v_exp_f32 v31, v31
    v_cvt_pk_bf16_f32 v58, v28, v29
    v_exp_f32 v32, v32
    v_cvt_pk_bf16_f32 v59, v30, v31
    v_exp_f32 v33, v33
    v_exp_f32 v34, v34
    v_exp_f32 v35, v35
    v_mfma_f32_32x32x16_bf16 v[8:23], v[72:75], v[56:59], v[8:23]
    v_cvt_pk_bf16_f32 v60, v32, v33
    v_exp_f32 v36, v36
    v_cvt_pk_bf16_f32 v61, v34, v35
    v_exp_f32 v37, v37
    v_exp_f32 v38, v38
    v_exp_f32 v39, v39
    v_cvt_pk_bf16_f32 v62, v36, v37
    v_cvt_pk_bf16_f32 v63, v38, v39
    s_waitcnt lgkmcnt(0)
    v_mfma_f32_32x32x16_bf16 v[24:39], v[68:71], v[4:7], 0
    ds_read_b128 v[64:67], v88 offset:8192
    v_exp_f32 v40, v40
    v_exp_f32 v41, v41
    v_exp_f32 v42, v42
    v_exp_f32 v43, v43
    v_cvt_pk_bf16_f32 v56, v40, v41
    v_mfma_f32_32x32x16_bf16 v[8:23], v[80:83], v[60:63], v[8:23]
    s_cmp_eq_u32 s78, 1
    s_cbranch_scc0 jo_32
    v_mov_b32 v128, 0x3f803f80
    v_mov_b32 v129, 0x3f803f80
    v_mov_b32 v130, 0x3f803f80
    v_mov_b32 v131, 0x3f803f80
    s_add_u32 s63, s59, 0
    buffer_store_dwordx4 v[112:115], v1, s[8:11], s63 offen sc1
    s_add_u32 s63, s59, 32768
    buffer_store_dwordx4 v[116:119], v1, s[8:11], s63 offen sc1
    s_add_u32 s63, s59, 65536
    buffer_store_dwordx4 v[120:123], v1, s[8:11], s63 offen sc1
    s_add_u32 s63, s59, 98304
    buffer_store_dwordx4 v[124:127], v1, s[8:11], s63 offen sc1
    v_mfma_f32_32x32x16_bf16 v[160:175], v[128:131], v[112:115], 0
    v_mfma_f32_32x32x16_bf16 v[176:191], v[128:131], v[116:119], 0
    v_mfma_f32_32x32x16_bf16 v[192:207], v[128:131], v[120:123], 0
    v_mfma_f32_32x32x16_bf16 v[208:223], v[128:131], v[124:127], 0
    s_branch je_33
jo_32:
    s_cmp_eq_u32 s78, 0
    s_cbranch_scc1 je_33
    s_mov_b32 s63, s59
    buffer_store_dwordx4 v[112:115], v1, s[8:11], s63 offen sc1
    s_add_u32 s63, s63, s72
    buffer_store_dwordx4 v[116:119], v1, s[8:11], s63 offen sc1
    s_add_u32 s63, s63, s72
    buffer_store_dwordx4 v[120:123], v1, s[8:11], s63 offen sc1
    s_add_u32 s63, s63, s72
    buffer_store_dwordx4 v[124:127], v1, s[8:11], s63 offen sc1
je_33:
    v_exp_f32 v44, v44
    v_cvt_pk_bf16_f32 v57, v42, v43
    v_exp_f32 v45, v45
    v_exp_f32 v46, v46
    v_exp_f32 v47, v47
    v_cvt_pk_bf16_f32 v58, v44, v45
    v_exp_f32 v48, v48
    v_cvt_pk_bf16_f32 v59, v46, v47
    v_exp_f32 v49, v49
    v_exp_f32 v50, v50
    v_exp_f32 v51, v51
    v_mfma_f32_32x32x16_bf16 v[96:111], v[72:75], v[56:59], v[96:111]
    v_cvt_pk_bf16_f32 v60, v48, v49
    v_exp_f32 v52, v52
    v_cvt_pk_bf16_f32 v61, v50, v51
    v_exp_f32 v53, v53
    v_exp_f32 v54, v54
    v_exp_f32 v55, v55
    v_cvt_pk_bf16_f32 v62, v52, v53
    v_cvt_pk_bf16_f32 v63, v54, v55
    s_waitcnt lgkmcnt(0)
    v_mfma_f32_32x32x16_bf16 v[40:55], v[68:71], v[92:95], 0
    v_exp_f32 v24, v24
    v_exp_f32 v25, v25
    v_exp_f32 v26, v26
    v_exp_f32 v27, v27
    v_cvt_pk_bf16_f32 v56, v24, v25
    v_mfma_f32_32x32x16_bf16 v[96:111], v[80:83], v[60:63], v[96:111]
    s_mov_b64 exec, s[70:71]
    ds_read_b128 v[72:75], v89 offset:8192
    ds_read_b128 v[80:83], v89 offset:8704
    s_mov_b64 exec, -1
    v_exp_f32 v28, v28
    v_cvt_pk_bf16_f32 v57, v26, v27
    v_exp_f32 v29, v29
    v_exp_f32 v30, v30
    v_exp_f32 v31, v31
    v_cvt_pk_bf16_f32 v58, v28, v29
    v_exp_f32 v32, v32
    v_cvt_pk_bf16_f32 v59, v30, v31
    v_exp_f32 v33, v33
    v_exp_f32 v34, v34
    v_exp_f32 v35, v35
    v_mfma_f32_32x32x16_bf16 v[8:23], v[76:79], v[56:59], v[8:23]
    v_cvt_pk_bf16_f32 v60, v32, v33
    v_exp_f32 v36, v36
    v_cvt_pk_bf16_f32 v61, v34, v35
    v_exp_f32 v37, v37
    v_exp_f32 v38, v38
    v_exp_f32 v39, v39
    v_cvt_pk_bf16_f32 v62, v36, v37
    v_cvt_pk_bf16_f32 v63, v38, v39
    s_waitcnt lgkmcnt(0)
    v_mfma_f32_32x32x16_bf16 v[24:39], v[64:67], v[4:7], 0
    ds_read_b128 v[68:71], v88 offset:9216
    v_exp_f32 v40, v40
    v_exp_f32 v41, v41
    v_exp_f32 v42, v42
    v_exp_f32 v43, v43
    v_cvt_pk_bf16_f32 v56, v40, v41
    v_mfma_f32_32x32x16_bf16 v[8:23], v[84:87], v[60:63], v[8:23]
    s_cmp_eq_u32 s78, 1
    s_cbranch_scc0 jo_34
    s_mov_b32 exec_hi, 0
    ds_write_b32 v142, v160 offset:0
    ds_write_b32 v142, v176 offset:128
    ds_write_b32 v142, v192 offset:256
    ds_write_b32 v142, v208 offset:384
    s_mov_b64 exec, -1
    s_branch je_35
jo_34:
je_35:
    v_exp_f32 v44, v44
    v_cvt_pk_bf16_f32 v57, v42, v43
    v_exp_f32 v45, v45
    v_exp_f32 v46, v46
    v_exp_f32 v47, v47
    v_cvt_pk_bf16_f32 v58, v44, v45
    v_exp_f32 v48, v48
    v_cvt_pk_bf16_f32 v59, v46, v47
    v_exp_f32 v49, v49
    v_exp_f32 v50, v50
    v_exp_f32 v51, v51
    v_mfma_f32_32x32x16_bf16 v[96:111], v[76:79], v[56:59], v[96:111]
    v_cvt_pk_bf16_f32 v60, v48, v49
    v_exp_f32 v52, v52
    v_cvt_pk_bf16_f32 v61, v50, v51
    v_exp_f32 v53, v53
    v_exp_f32 v54, v54
    v_exp_f32 v55, v55
    v_cvt_pk_bf16_f32 v62, v52, v53
    v_cvt_pk_bf16_f32 v63, v54, v55
    v_add_u32 v88, 8192, v88
    v_add_u32 v89, 8192, v89
    s_waitcnt lgkmcnt(0)
    s_barrier
    s_waitcnt lgkmcnt(0)
    v_mfma_f32_32x32x16_bf16 v[40:55], v[64:67], v[92:95], 0
    v_exp_f32 v24, v24
    v_exp_f32 v25, v25
    v_exp_f32 v26, v26
    v_exp_f32 v27, v27
    v_cvt_pk_bf16_f32 v56, v24, v25
    v_mfma_f32_32x32x16_bf16 v[96:111], v[84:87], v[60:63], v[96:111]
    s_mov_b64 exec, s[70:71]
    ds_read_b128 v[76:79], v89 offset:1024
    ds_read_b128 v[84:87], v89 offset:1536
    s_mov_b64 exec, -1
    s_cmp_eq_u32 s78, 1
    s_cbranch_scc0 jo_36
    s_cmp_ge_u32 s4, 2
    s_cbranch_scc1 csr_38
    s_lshl_b32 s63, s4, 8
    v_lshlrev_b32 v132, 2, v0
    v_add_u32 v132, s63, v132
    v_add_u32 v133, 131072, v132
    ds_read_b32 v112, v133 offset:0
    ds_read_b32 v113, v133 offset:4096
    ds_read_b32 v114, v133 offset:8192
    ds_read_b32 v115, v133 offset:12288
    ds_read_b32 v116, v133 offset:16384
    ds_read_b32 v117, v133 offset:20480
    ds_read_b32 v118, v133 offset:24576
    ds_read_b32 v119, v133 offset:28672
csr_38:
    s_branch je_37
jo_36:
je_37:
    v_exp_f32 v28, v28
    v_cvt_pk_bf16_f32 v57, v26, v27
    v_exp_f32 v29, v29
    v_exp_f32 v30, v30
    v_exp_f32 v31, v31
    v_cvt_pk_bf16_f32 v58, v28, v29
    v_exp_f32 v32, v32
    v_cvt_pk_bf16_f32 v59, v30, v31
    v_exp_f32 v33, v33
    v_exp_f32 v34, v34
    v_exp_f32 v35, v35
    v_mfma_f32_32x32x16_bf16 v[8:23], v[72:75], v[56:59], v[8:23]
    v_cvt_pk_bf16_f32 v60, v32, v33
    v_exp_f32 v36, v36
    v_cvt_pk_bf16_f32 v61, v34, v35
    v_exp_f32 v37, v37
    v_exp_f32 v38, v38
    v_exp_f32 v39, v39
    v_cvt_pk_bf16_f32 v62, v36, v37
    v_cvt_pk_bf16_f32 v63, v38, v39
    s_waitcnt lgkmcnt(0)
    v_mfma_f32_32x32x16_bf16 v[24:39], v[68:71], v[4:7], 0
    ds_read_b128 v[64:67], v88 offset:2048
    v_exp_f32 v40, v40
    v_exp_f32 v41, v41
    v_exp_f32 v42, v42
    v_exp_f32 v43, v43
    v_cvt_pk_bf16_f32 v56, v40, v41
    v_mfma_f32_32x32x16_bf16 v[8:23], v[80:83], v[60:63], v[8:23]
    s_cmp_eq_u32 s78, 1
    s_cbranch_scc0 jo_39
    s_cmp_ge_u32 s4, 2
    s_cbranch_scc1 css_41
    v_add_f32 v112, v112, v113
    v_add_f32 v112, v112, v114
    v_add_f32 v112, v112, v115
    v_add_f32 v112, v112, v116
    v_add_f32 v112, v112, v117
    v_add_f32 v112, v112, v118
    v_add_f32 v112, v112, v119
    buffer_store_dword v112, v132, s[8:11], s72 offen sc1
css_41:
    s_branch je_40
jo_39:
je_40:
    v_exp_f32 v44, v44
    v_cvt_pk_bf16_f32 v57, v42, v43
    v_exp_f32 v45, v45
    v_exp_f32 v46, v46
    v_exp_f32 v47, v47
    v_cvt_pk_bf16_f32 v58, v44, v45
    v_exp_f32 v48, v48
    v_cvt_pk_bf16_f32 v59, v46, v47
    v_exp_f32 v49, v49
    v_exp_f32 v50, v50
    v_exp_f32 v51, v51
    v_mfma_f32_32x32x16_bf16 v[96:111], v[72:75], v[56:59], v[96:111]
    v_cvt_pk_bf16_f32 v60, v48, v49
    v_exp_f32 v52, v52
    v_cvt_pk_bf16_f32 v61, v50, v51
    v_exp_f32 v53, v53
    v_exp_f32 v54, v54
    v_exp_f32 v55, v55
    v_cvt_pk_bf16_f32 v62, v52, v53
    v_cvt_pk_bf16_f32 v63, v54, v55
    s_waitcnt lgkmcnt(0)
    v_mfma_f32_32x32x16_bf16 v[40:55], v[68:71], v[92:95], 0
    v_exp_f32 v24, v24
    v_exp_f32 v25, v25
    v_exp_f32 v26, v26
    v_exp_f32 v27, v27
    v_cvt_pk_bf16_f32 v56, v24, v25
    v_mfma_f32_32x32x16_bf16 v[96:111], v[80:83], v[60:63], v[96:111]
    s_mov_b64 exec, s[70:71]
    ds_read_b128 v[72:75], v89 offset:2048
    ds_read_b128 v[80:83], v89 offset:2560
    s_mov_b64 exec, -1
    v_exp_f32 v28, v28
    v_cvt_pk_bf16_f32 v57, v26, v27
    v_exp_f32 v29, v29
    v_exp_f32 v30, v30
    v_exp_f32 v31, v31
    v_cvt_pk_bf16_f32 v58, v28, v29
    v_exp_f32 v32, v32
    v_cvt_pk_bf16_f32 v59, v30, v31
    v_exp_f32 v33, v33
    v_exp_f32 v34, v34
    v_exp_f32 v35, v35
    v_mfma_f32_32x32x16_bf16 v[8:23], v[76:79], v[56:59], v[8:23]
    v_cvt_pk_bf16_f32 v60, v32, v33
    v_exp_f32 v36, v36
    v_cvt_pk_bf16_f32 v61, v34, v35
    v_exp_f32 v37, v37
    v_exp_f32 v38, v38
    v_exp_f32 v39, v39
    v_cvt_pk_bf16_f32 v62, v36, v37
    v_cvt_pk_bf16_f32 v63, v38, v39
    s_waitcnt lgkmcnt(0)
    v_mfma_f32_32x32x16_bf16 v[24:39], v[64:67], v[4:7], 0
    ds_read_b128 v[68:71], v88 offset:3072
    v_exp_f32 v40, v40
    v_exp_f32 v41, v41
    v_exp_f32 v42, v42
    v_exp_f32 v43, v43
    v_cvt_pk_bf16_f32 v56, v40, v41
    v_mfma_f32_32x32x16_bf16 v[8:23], v[84:87], v[60:63], v[8:23]
    v_exp_f32 v44, v44
    v_cvt_pk_bf16_f32 v57, v42, v43
    v_exp_f32 v45, v45
    v_exp_f32 v46, v46
    v_exp_f32 v47, v47
    v_cvt_pk_bf16_f32 v58, v44, v45
    v_exp_f32 v48, v48
    v_cvt_pk_bf16_f32 v59, v46, v47
    v_exp_f32 v49, v49
    v_exp_f32 v50, v50
    v_exp_f32 v51, v51
    v_mfma_f32_32x32x16_bf16 v[96:111], v[76:79], v[56:59], v[96:111]
    v_cvt_pk_bf16_f32 v60, v48, v49
    v_exp_f32 v52, v52
    v_cvt_pk_bf16_f32 v61, v50, v51
    v_exp_f32 v53, v53
    v_exp_f32 v54, v54
    v_exp_f32 v55, v55
    v_cvt_pk_bf16_f32 v62, v52, v53
    v_cvt_pk_bf16_f32 v63, v54, v55
    s_waitcnt lgkmcnt(0)
    v_mfma_f32_32x32x16_bf16 v[40:55], v[64:67], v[92:95], 0
    v_exp_f32 v24, v24
    v_exp_f32 v25, v25
    v_exp_f32 v26, v26
    v_exp_f32 v27, v27
    v_cvt_pk_bf16_f32 v56, v24, v25
    v_mfma_f32_32x32x16_bf16 v[96:111], v[84:87], v[60:63], v[96:111]
    s_mov_b64 exec, s[70:71]
    ds_read_b128 v[76:79], v89 offset:3072
    ds_read_b128 v[84:87], v89 offset:3584
    s_mov_b64 exec, -1
    v_exp_f32 v28, v28
    v_cvt_pk_bf16_f32 v57, v26, v27
    v_exp_f32 v29, v29
    v_exp_f32 v30, v30
    v_exp_f32 v31, v31
    v_cvt_pk_bf16_f32 v58, v28, v29
    v_exp_f32 v32, v32
    v_cvt_pk_bf16_f32 v59, v30, v31
    v_exp_f32 v33, v33
    v_exp_f32 v34, v34
    v_exp_f32 v35, v35
    v_mfma_f32_32x32x16_bf16 v[8:23], v[72:75], v[56:59], v[8:23]
    v_cvt_pk_bf16_f32 v60, v32, v33
    v_exp_f32 v36, v36
    v_cvt_pk_bf16_f32 v61, v34, v35
    v_exp_f32 v37, v37
    v_exp_f32 v38, v38
    v_exp_f32 v39, v39
    v_cvt_pk_bf16_f32 v62, v36, v37
    v_cvt_pk_bf16_f32 v63, v38, v39
    s_waitcnt lgkmcnt(0)
    v_mfma_f32_32x32x16_bf16 v[24:39], v[68:71], v[4:7], 0
    ds_read_b128 v[64:67], v88 offset:4096
    v_exp_f32 v40, v40
    v_exp_f32 v41, v41
    v_exp_f32 v42, v42
    v_exp_f32 v43, v43
    v_cvt_pk_bf16_f32 v56, v40, v41
    v_mfma_f32_32x32x16_bf16 v[8:23], v[80:83], v[60:63], v[8:23]
    v_exp_f32 v44, v44
    v_cvt_pk_bf16_f32 v57, v42, v43
    v_exp_f32 v45, v45
    v_exp_f32 v46, v46
    v_exp_f32 v47, v47
    v_cvt_pk_bf16_f32 v58, v44, v45
    v_exp_f32 v48, v48
    v_cvt_pk_bf16_f32 v59, v46, v47
    v_exp_f32 v49, v49
    v_exp_f32 v50, v50
    v_exp_f32 v51, v51
    v_mfma_f32_32x32x16_bf16 v[96:111], v[72:75], v[56:59], v[96:111]
    v_cvt_pk_bf16_f32 v60, v48, v49
    v_exp_f32 v52, v52
    v_cvt_pk_bf16_f32 v61, v50, v51
    v_exp_f32 v53, v53
    v_exp_f32 v54, v54
    v_exp_f32 v55, v55
    v_cvt_pk_bf16_f32 v62, v52, v53
    v_cvt_pk_bf16_f32 v63, v54, v55
    s_waitcnt lgkmcnt(0)
    v_mfma_f32_32x32x16_bf16 v[40:55], v[68:71], v[92:95], 0
    v_exp_f32 v24, v24
    v_exp_f32 v25, v25
    v_exp_f32 v26, v26
    v_exp_f32 v27, v27
    v_cvt_pk_bf16_f32 v56, v24, v25
    v_mfma_f32_32x32x16_bf16 v[96:111], v[80:83], v[60:63], v[96:111]
    s_mov_b64 exec, s[70:71]
    ds_read_b128 v[72:75], v89 offset:4096
    ds_read_b128 v[80:83], v89 offset:4608
    s_mov_b64 exec, -1
    v_exp_f32 v28, v28
    v_cvt_pk_bf16_f32 v57, v26, v27
    v_exp_f32 v29, v29
    v_exp_f32 v30, v30
    v_exp_f32 v31, v31
    v_cvt_pk_bf16_f32 v58, v28, v29
    v_exp_f32 v32, v32
    v_cvt_pk_bf16_f32 v59, v30, v31
    v_exp_f32 v33, v33
    v_exp_f32 v34, v34
    v_exp_f32 v35, v35
    v_mfma_f32_32x32x16_bf16 v[8:23], v[76:79], v[56:59], v[8:23]
    v_cvt_pk_bf16_f32 v60, v32, v33
    v_exp_f32 v36, v36
    v_cvt_pk_bf16_f32 v61, v34, v35
    v_exp_f32 v37, v37
    v_exp_f32 v38, v38
    v_exp_f32 v39, v39
    v_cvt_pk_bf16_f32 v62, v36, v37
    v_cvt_pk_bf16_f32 v63, v38, v39
    s_waitcnt lgkmcnt(0)
    v_mfma_f32_32x32x16_bf16 v[24:39], v[64:67], v[4:7], 0
    ds_read_b128 v[68:71], v88 offset:5120
    v_exp_f32 v40, v40
    v_exp_f32 v41, v41
    v_exp_f32 v42, v42
    v_exp_f32 v43, v43
    v_cvt_pk_bf16_f32 v56, v40, v41
    v_mfma_f32_32x32x16_bf16 v[8:23], v[84:87], v[60:63], v[8:23]
    v_exp_f32 v44, v44
    v_cvt_pk_bf16_f32 v57, v42, v43
    v_exp_f32 v45, v45
    v_exp_f32 v46, v46
    v_exp_f32 v47, v47
    v_cvt_pk_bf16_f32 v58, v44, v45
    v_exp_f32 v48, v48
    v_cvt_pk_bf16_f32 v59, v46, v47
    v_exp_f32 v49, v49
    v_exp_f32 v50, v50
    v_exp_f32 v51, v51
    v_mfma_f32_32x32x16_bf16 v[96:111], v[76:79], v[56:59], v[96:111]
    v_cvt_pk_bf16_f32 v60, v48, v49
    v_exp_f32 v52, v52
    v_cvt_pk_bf16_f32 v61, v50, v51
    v_exp_f32 v53, v53
    v_exp_f32 v54, v54
    v_exp_f32 v55, v55
    v_cvt_pk_bf16_f32 v62, v52, v53
    v_cvt_pk_bf16_f32 v63, v54, v55
    s_waitcnt vmcnt(0)
    s_barrier
    s_cmp_eq_u32 s78, 0
    s_cbranch_scc1 wsig_42
    s_cmp_lg_u32 s4, 0
    s_cbranch_scc1 wsig_42
    s_lshl_b32 s63, s2, 7
    s_add_u32 s63, s63, 23142400
    v_mov_b32 v112, s56
    v_lshlrev_b32 v113, 2, v0
    s_mov_b32 exec_hi, 0
    buffer_store_dword v112, v113, s[8:11], s63 offen sc1
    s_mov_b64 exec, -1
wsig_42:
    s_waitcnt lgkmcnt(0)
    v_mfma_f32_32x32x16_bf16 v[40:55], v[64:67], v[92:95], 0
    v_exp_f32 v24, v24
    v_exp_f32 v25, v25
    v_exp_f32 v26, v26
    v_exp_f32 v27, v27
    v_cvt_pk_bf16_f32 v56, v24, v25
    v_mfma_f32_32x32x16_bf16 v[96:111], v[84:87], v[60:63], v[96:111]
    s_mov_b64 exec, s[70:71]
    ds_read_b128 v[76:79], v89 offset:5120
    ds_read_b128 v[84:87], v89 offset:5632
    s_mov_b64 exec, -1
    v_exp_f32 v28, v28
    v_cvt_pk_bf16_f32 v57, v26, v27
    v_exp_f32 v29, v29
    v_exp_f32 v30, v30
    v_exp_f32 v31, v31
    v_cvt_pk_bf16_f32 v58, v28, v29
    v_exp_f32 v32, v32
    v_cvt_pk_bf16_f32 v59, v30, v31
    v_exp_f32 v33, v33
    v_exp_f32 v34, v34
    v_exp_f32 v35, v35
    v_mfma_f32_32x32x16_bf16 v[8:23], v[72:75], v[56:59], v[8:23]
    v_cvt_pk_bf16_f32 v60, v32, v33
    v_exp_f32 v36, v36
    v_cvt_pk_bf16_f32 v61, v34, v35
    v_exp_f32 v37, v37
    v_exp_f32 v38, v38
    v_exp_f32 v39, v39
    v_cvt_pk_bf16_f32 v62, v36, v37
    v_cvt_pk_bf16_f32 v63, v38, v39
    s_waitcnt lgkmcnt(0)
    v_mfma_f32_32x32x16_bf16 v[24:39], v[68:71], v[4:7], 0
    ds_read_b128 v[64:67], v88 offset:6144
    v_exp_f32 v40, v40
    v_exp_f32 v41, v41
    v_exp_f32 v42, v42
    v_exp_f32 v43, v43
    v_cvt_pk_bf16_f32 v56, v40, v41
    v_mfma_f32_32x32x16_bf16 v[8:23], v[80:83], v[60:63], v[8:23]
    v_exp_f32 v44, v44
    v_cvt_pk_bf16_f32 v57, v42, v43
    v_exp_f32 v45, v45
    v_exp_f32 v46, v46
    v_exp_f32 v47, v47
    v_cvt_pk_bf16_f32 v58, v44, v45
    v_exp_f32 v48, v48
    v_cvt_pk_bf16_f32 v59, v46, v47
    v_exp_f32 v49, v49
    v_exp_f32 v50, v50
    v_exp_f32 v51, v51
    v_mfma_f32_32x32x16_bf16 v[96:111], v[72:75], v[56:59], v[96:111]
    v_cvt_pk_bf16_f32 v60, v48, v49
    v_exp_f32 v52, v52
    v_cvt_pk_bf16_f32 v61, v50, v51
    v_exp_f32 v53, v53
    v_exp_f32 v54, v54
    v_exp_f32 v55, v55
    v_cvt_pk_bf16_f32 v62, v52, v53
    v_cvt_pk_bf16_f32 v63, v54, v55
    s_waitcnt lgkmcnt(0)
    v_mfma_f32_32x32x16_bf16 v[40:55], v[68:71], v[92:95], 0
    v_exp_f32 v24, v24
    v_exp_f32 v25, v25
    v_exp_f32 v26, v26
    v_exp_f32 v27, v27
    v_cvt_pk_bf16_f32 v56, v24, v25
    v_mfma_f32_32x32x16_bf16 v[96:111], v[80:83], v[60:63], v[96:111]
    s_mov_b64 exec, s[70:71]
    ds_read_b128 v[72:75], v89 offset:6144
    ds_read_b128 v[80:83], v89 offset:6656
    s_mov_b64 exec, -1
    v_exp_f32 v28, v28
    v_cvt_pk_bf16_f32 v57, v26, v27
    v_exp_f32 v29, v29
    v_exp_f32 v30, v30
    v_exp_f32 v31, v31
    v_cvt_pk_bf16_f32 v58, v28, v29
    v_exp_f32 v32, v32
    v_cvt_pk_bf16_f32 v59, v30, v31
    v_exp_f32 v33, v33
    v_exp_f32 v34, v34
    v_exp_f32 v35, v35
    v_mfma_f32_32x32x16_bf16 v[8:23], v[76:79], v[56:59], v[8:23]
    v_cvt_pk_bf16_f32 v60, v32, v33
    v_exp_f32 v36, v36
    v_cvt_pk_bf16_f32 v61, v34, v35
    v_exp_f32 v37, v37
    v_exp_f32 v38, v38
    v_exp_f32 v39, v39
    v_cvt_pk_bf16_f32 v62, v36, v37
    v_cvt_pk_bf16_f32 v63, v38, v39
    s_waitcnt lgkmcnt(0)
    v_mfma_f32_32x32x16_bf16 v[24:39], v[64:67], v[4:7], 0
    ds_read_b128 v[68:71], v88 offset:7168
    v_exp_f32 v40, v40
    v_exp_f32 v41, v41
    v_exp_f32 v42, v42
    v_exp_f32 v43, v43
    v_cvt_pk_bf16_f32 v56, v40, v41
    v_mfma_f32_32x32x16_bf16 v[8:23], v[84:87], v[60:63], v[8:23]
    v_exp_f32 v44, v44
    v_cvt_pk_bf16_f32 v57, v42, v43
    v_exp_f32 v45, v45
    v_exp_f32 v46, v46
    v_exp_f32 v47, v47
    v_cvt_pk_bf16_f32 v58, v44, v45
    v_exp_f32 v48, v48
    v_cvt_pk_bf16_f32 v59, v46, v47
    v_exp_f32 v49, v49
    v_exp_f32 v50, v50
    v_exp_f32 v51, v51
    v_mfma_f32_32x32x16_bf16 v[96:111], v[76:79], v[56:59], v[96:111]
    v_cvt_pk_bf16_f32 v60, v48, v49
    v_exp_f32 v52, v52
    v_cvt_pk_bf16_f32 v61, v50, v51
    v_exp_f32 v53, v53
    v_exp_f32 v54, v54
    v_exp_f32 v55, v55
    v_cvt_pk_bf16_f32 v62, v52, v53
    v_cvt_pk_bf16_f32 v63, v54, v55
    s_waitcnt lgkmcnt(0)
    v_mfma_f32_32x32x16_bf16 v[40:55], v[64:67], v[92:95], 0
    v_exp_f32 v24, v24
    v_exp_f32 v25, v25
    v_exp_f32 v26, v26
    v_exp_f32 v27, v27
    v_cvt_pk_bf16_f32 v56, v24, v25
    v_mfma_f32_32x32x16_bf16 v[96:111], v[84:87], v[60:63], v[96:111]
    s_mov_b64 exec, s[70:71]
    ds_read_b128 v[76:79], v89 offset:7168
    ds_read_b128 v[84:87], v89 offset:7680
    s_mov_b64 exec, -1
    v_exp_f32 v28, v28
    v_cvt_pk_bf16_f32 v57, v26, v27
    v_exp_f32 v29, v29
    v_exp_f32 v30, v30
    v_exp_f32 v31, v31
    v_cvt_pk_bf16_f32 v58, v28, v29
    v_exp_f32 v32, v32
    v_cvt_pk_bf16_f32 v59, v30, v31
    v_exp_f32 v33, v33
    v_exp_f32 v34, v34
    v_exp_f32 v35, v35
    v_mfma_f32_32x32x16_bf16 v[8:23], v[72:75], v[56:59], v[8:23]
    v_cvt_pk_bf16_f32 v60, v32, v33
    v_exp_f32 v36, v36
    v_cvt_pk_bf16_f32 v61, v34, v35
    v_exp_f32 v37, v37
    v_exp_f32 v38, v38
    v_exp_f32 v39, v39
    v_cvt_pk_bf16_f32 v62, v36, v37
    v_cvt_pk_bf16_f32 v63, v38, v39
    s_waitcnt lgkmcnt(0)
    v_mfma_f32_32x32x16_bf16 v[24:39], v[68:71], v[4:7], 0
    ds_read_b128 v[64:67], v88 offset:8192
    v_exp_f32 v40, v40
    v_exp_f32 v41, v41
    v_exp_f32 v42, v42
    v_exp_f32 v43, v43
    v_cvt_pk_bf16_f32 v56, v40, v41
    v_mfma_f32_32x32x16_bf16 v[8:23], v[80:83], v[60:63], v[8:23]
    v_exp_f32 v44, v44
    v_cvt_pk_bf16_f32 v57, v42, v43
    v_exp_f32 v45, v45
    v_exp_f32 v46, v46
    v_exp_f32 v47, v47
    v_cvt_pk_bf16_f32 v58, v44, v45
    v_exp_f32 v48, v48
    v_cvt_pk_bf16_f32 v59, v46, v47
    v_exp_f32 v49, v49
    v_exp_f32 v50, v50
    v_exp_f32 v51, v51
    v_mfma_f32_32x32x16_bf16 v[96:111], v[72:75], v[56:59], v[96:111]
    v_cvt_pk_bf16_f32 v60, v48, v49
    v_exp_f32 v52, v52
    v_cvt_pk_bf16_f32 v61, v50, v51
    v_exp_f32 v53, v53
    v_exp_f32 v54, v54
    v_exp_f32 v55, v55
    v_cvt_pk_bf16_f32 v62, v52, v53
    v_cvt_pk_bf16_f32 v63, v54, v55
    s_waitcnt lgkmcnt(0)
    v_mfma_f32_32x32x16_bf16 v[40:55], v[68:71], v[92:95], 0
    v_exp_f32 v24, v24
    v_exp_f32 v25, v25
    v_exp_f32 v26, v26
    v_exp_f32 v27, v27
    v_cvt_pk_bf16_f32 v56, v24, v25
    v_mfma_f32_32x32x16_bf16 v[96:111], v[80:83], v[60:63], v[96:111]
    s_mov_b64 exec, s[70:71]
    ds_read_b128 v[72:75], v89 offset:8192
    ds_read_b128 v[80:83], v89 offset:8704
    s_mov_b64 exec, -1
    v_exp_f32 v28, v28
    v_cvt_pk_bf16_f32 v57, v26, v27
    v_exp_f32 v29, v29
    v_exp_f32 v30, v30
    v_exp_f32 v31, v31
    v_cvt_pk_bf16_f32 v58, v28, v29
    v_exp_f32 v32, v32
    v_cvt_pk_bf16_f32 v59, v30, v31
    v_exp_f32 v33, v33
    v_exp_f32 v34, v34
    v_exp_f32 v35, v35
    v_mfma_f32_32x32x16_bf16 v[8:23], v[76:79], v[56:59], v[8:23]
    v_cvt_pk_bf16_f32 v60, v32, v33
    v_exp_f32 v36, v36
    v_cvt_pk_bf16_f32 v61, v34, v35
    v_exp_f32 v37, v37
    v_exp_f32 v38, v38
    v_exp_f32 v39, v39
    v_cvt_pk_bf16_f32 v62, v36, v37
    v_cvt_pk_bf16_f32 v63, v38, v39
    s_waitcnt lgkmcnt(0)
    v_mfma_f32_32x32x16_bf16 v[24:39], v[64:67], v[4:7], 0
    ds_read_b128 v[68:71], v88 offset:9216
    v_exp_f32 v40, v40
    v_exp_f32 v41, v41
    v_exp_f32 v42, v42
    v_exp_f32 v43, v43
    v_cvt_pk_bf16_f32 v56, v40, v41
    v_mfma_f32_32x32x16_bf16 v[8:23], v[84:87], v[60:63], v[8:23]
    v_exp_f32 v44, v44
    v_cvt_pk_bf16_f32 v57, v42, v43
    v_exp_f32 v45, v45
    v_exp_f32 v46, v46
    v_exp_f32 v47, v47
    v_cvt_pk_bf16_f32 v58, v44, v45
    v_exp_f32 v48, v48
    v_cvt_pk_bf16_f32 v59, v46, v47
    v_exp_f32 v49, v49
    v_exp_f32 v50, v50
    v_exp_f32 v51, v51
    v_mfma_f32_32x32x16_bf16 v[96:111], v[76:79], v[56:59], v[96:111]
    v_cvt_pk_bf16_f32 v60, v48, v49
    v_exp_f32 v52, v52
    v_cvt_pk_bf16_f32 v61, v50, v51
    v_exp_f32 v53, v53
    v_exp_f32 v54, v54
    v_exp_f32 v55, v55
    v_cvt_pk_bf16_f32 v62, v52, v53
    v_cvt_pk_bf16_f32 v63, v54, v55
    v_add_u32 v88, 8192, v88
    v_add_u32 v89, 8192, v89
    s_barrier
    s_waitcnt lgkmcnt(0)
    v_mfma_f32_32x32x16_bf16 v[40:55], v[64:67], v[92:95], 0
    v_exp_f32 v24, v24
    v_exp_f32 v25, v25
    v_exp_f32 v26, v26
    v_exp_f32 v27, v27
    v_cvt_pk_bf16_f32 v56, v24, v25
    v_mfma_f32_32x32x16_bf16 v[96:111], v[84:87], v[60:63], v[96:111]
    s_mov_b64 exec, s[70:71]
    ds_read_b128 v[76:79], v89 offset:1024
    ds_read_b128 v[84:87], v89 offset:1536
    s_mov_b64 exec, -1
    v_exp_f32 v28, v28
    v_cvt_pk_bf16_f32 v57, v26, v27
    v_exp_f32 v29, v29
    v_exp_f32 v30, v30
    v_exp_f32 v31, v31
    v_cvt_pk_bf16_f32 v58, v28, v29
    v_exp_f32 v32, v32
    v_cvt_pk_bf16_f32 v59, v30, v31
    v_exp_f32 v33, v33
    v_exp_f32 v34, v34
    v_exp_f32 v35, v35
    v_mfma_f32_32x32x16_bf16 v[8:23], v[72:75], v[56:59], v[8:23]
    v_cvt_pk_bf16_f32 v60, v32, v33
    v_exp_f32 v36, v36
    v_cvt_pk_bf16_f32 v61, v34, v35
    v_exp_f32 v37, v37
    v_exp_f32 v38, v38
    v_exp_f32 v39, v39
    v_cvt_pk_bf16_f32 v62, v36, v37
    v_cvt_pk_bf16_f32 v63, v38, v39
    s_waitcnt lgkmcnt(0)
    v_mfma_f32_32x32x16_bf16 v[24:39], v[68:71], v[4:7], 0
    ds_read_b128 v[64:67], v88 offset:2048
    v_exp_f32 v40, v40
    v_exp_f32 v41, v41
    v_exp_f32 v42, v42
    v_exp_f32 v43, v43
    v_cvt_pk_bf16_f32 v56, v40, v41
    v_mfma_f32_32x32x16_bf16 v[8:23], v[80:83], v[60:63], v[8:23]
    s_cmp_lg_u32 s4, 0
    s_cbranch_scc1 wrq_43
    v_lshlrev_b32 v2, 7, v0
    v_add_u32 v3, 128, v0
    v_min_u32 v3, 183, v3
    v_lshlrev_b32 v3, 7, v3
    s_mov_b32 s63, 23142400
    buffer_load_dword v112, v2, s[8:11], s63 offen sc1
    s_mov_b32 s63, 23150592
    buffer_load_dword v113, v2, s[8:11], s63 offen sc1
    s_mov_b32 s63, 23142400
    buffer_load_dword v114, v3, s[8:11], s63 offen sc1
wrq_43:
    v_lshlrev_b32 v118, 7, v0
    s_lshl_b32 s62, s5, 11
    s_add_u32 s62, s62, 23207936
    s_mov_b64 exec, 0xffff
    buffer_load_dwordx2 v[116:117], v118, s[8:11], s62 offen sc1
    s_mov_b64 exec, -1
    v_exp_f32 v44, v44
    v_cvt_pk_bf16_f32 v57, v42, v43
    v_exp_f32 v45, v45
    v_exp_f32 v46, v46
    v_exp_f32 v47, v47
    v_cvt_pk_bf16_f32 v58, v44, v45
    v_exp_f32 v48, v48
    v_cvt_pk_bf16_f32 v59, v46, v47
    v_exp_f32 v49, v49
    v_exp_f32 v50, v50
    v_exp_f32 v51, v51
    v_mfma_f32_32x32x16_bf16 v[96:111], v[72:75], v[56:59], v[96:111]
    v_cvt_pk_bf16_f32 v60, v48, v49
    v_exp_f32 v52, v52
    v_cvt_pk_bf16_f32 v61, v50, v51
    v_exp_f32 v53, v53
    v_exp_f32 v54, v54
    v_exp_f32 v55, v55
    v_cvt_pk_bf16_f32 v62, v52, v53
    v_cvt_pk_bf16_f32 v63, v54, v55
    s_waitcnt lgkmcnt(0)
    v_mfma_f32_32x32x16_bf16 v[40:55], v[68:71], v[92:95], 0
    v_exp_f32 v24, v24
    v_exp_f32 v25, v25
    v_exp_f32 v26, v26
    v_exp_f32 v27, v27
    v_cvt_pk_bf16_f32 v56, v24, v25
    v_mfma_f32_32x32x16_bf16 v[96:111], v[80:83], v[60:63], v[96:111]
    s_mov_b64 exec, s[70:71]
    ds_read_b128 v[72:75], v89 offset:2048
    ds_read_b128 v[80:83], v89 offset:2560
    s_mov_b64 exec, -1
    v_exp_f32 v28, v28
    v_cvt_pk_bf16_f32 v57, v26, v27
    v_exp_f32 v29, v29
    v_exp_f32 v30, v30
    v_exp_f32 v31, v31
    v_cvt_pk_bf16_f32 v58, v28, v29
    v_exp_f32 v32, v32
    v_cvt_pk_bf16_f32 v59, v30, v31
    v_exp_f32 v33, v33
    v_exp_f32 v34, v34
    v_exp_f32 v35, v35
    v_mfma_f32_32x32x16_bf16 v[8:23], v[76:79], v[56:59], v[8:23]
    v_cvt_pk_bf16_f32 v60, v32, v33
    v_exp_f32 v36, v36
    v_cvt_pk_bf16_f32 v61, v34, v35
    v_exp_f32 v37, v37
    v_exp_f32 v38, v38
    v_exp_f32 v39, v39
    v_cvt_pk_bf16_f32 v62, v36, v37
    v_cvt_pk_bf16_f32 v63, v38, v39
    s_waitcnt lgkmcnt(0)
    v_mfma_f32_32x32x16_bf16 v[24:39], v[64:67], v[4:7], 0
    ds_read_b128 v[68:71], v88 offset:3072
    v_exp_f32 v40, v40
    v_exp_f32 v41, v41
    v_exp_f32 v42, v42
    v_exp_f32 v43, v43
    v_cvt_pk_bf16_f32 v56, v40, v41
    v_mfma_f32_32x32x16_bf16 v[8:23], v[84:87], v[60:63], v[8:23]
    v_exp_f32 v44, v44
    v_cvt_pk_bf16_f32 v57, v42, v43
    v_exp_f32 v45, v45
    v_exp_f32 v46, v46
    v_exp_f32 v47, v47
    v_cvt_pk_bf16_f32 v58, v44, v45
    v_exp_f32 v48, v48
    v_cvt_pk_bf16_f32 v59, v46, v47
    v_exp_f32 v49, v49
    v_exp_f32 v50, v50
    v_exp_f32 v51, v51
    v_mfma_f32_32x32x16_bf16 v[96:111], v[76:79], v[56:59], v[96:111]
    v_cvt_pk_bf16_f32 v60, v48, v49
    v_exp_f32 v52, v52
    v_cvt_pk_bf16_f32 v61, v50, v51
    v_exp_f32 v53, v53
    v_exp_f32 v54, v54
    v_exp_f32 v55, v55
    v_cvt_pk_bf16_f32 v62, v52, v53
    v_cvt_pk_bf16_f32 v63, v54, v55
    s_cmp_lg_u32 s4, 0
    s_cbranch_scc1 wrc_44
    s_waitcnt vmcnt(0)
    v_cmp_ne_u32 vcc, s56, v112
    v_cmp_ne_u32 s[62:63], s56, v113
    s_nop 1
    s_or_b64 s[62:63], s[62:63], vcc
    v_cmp_ne_u32 vcc, s56, v114
    s_nop 4
    s_or_b64 vcc, vcc, s[62:63]
    s_cbranch_vccz wrd_45
    s_mov_b32 s79, 400000
wrp_46:
    s_mov_b32 s63, 23142400
    buffer_load_dword v112, v2, s[8:11], s63 offen sc1
    buffer_load_dword v114, v3, s[8:11], s63 offen sc1
    s_mov_b32 s63, 23150592
    buffer_load_dword v113, v2, s[8:11], s63 offen sc1
    s_waitcnt vmcnt(0)
    v_cmp_ne_u32 vcc, s56, v112
    v_cmp_ne_u32 s[62:63], s56, v113
    s_nop 1
    s_or_b64 s[62:63], s[62:63], vcc
    v_cmp_ne_u32 vcc, s56, v114
    s_nop 4
    s_or_b64 vcc, vcc, s[62:63]
    s_nop 4
    s_cbranch_vccz wrd_45
    s_sleep 4
    s_sub_u32 s79, s79, 1
    s_cmp_lg_u32 s79, 0
    s_cbranch_scc1 wrp_46
wrd_45:
wrc_44:
    s_barrier
    s_waitcnt lgkmcnt(0)
    v_mfma_f32_32x32x16_bf16 v[40:55], v[64:67], v[92:95], 0
    v_exp_f32 v24, v24
    v_exp_f32 v25, v25
    v_exp_f32 v26, v26
    v_exp_f32 v27, v27
    v_cvt_pk_bf16_f32 v56, v24, v25
    v_mfma_f32_32x32x16_bf16 v[96:111], v[84:87], v[60:63], v[96:111]
    s_mov_b64 exec, s[70:71]
    ds_read_b128 v[76:79], v89 offset:3072
    ds_read_b128 v[84:87], v89 offset:3584
    s_mov_b64 exec, -1
    s_lshl_b32 s62, s5, 11
    s_add_u32 s62, s62, 23207936
    s_mov_b64 exec, 0xffff
    s_waitcnt vmcnt(0)
    v_cmp_ne_u32 vcc, s56, v116
    s_nop 4
    s_cbranch_vccz lcd_47
    s_mov_b32 s79, 400000
lcp_48:
    buffer_load_dwordx2 v[116:117], v118, s[8:11], s62 offen sc1
    s_waitcnt vmcnt(0)
    v_cmp_ne_u32 vcc, s56, v116
    s_nop 4
    s_cbranch_vccz lcd_47
    s_sleep 4
    s_sub_u32 s79, s79, 1
    s_cmp_lg_u32 s79, 0
    s_cbranch_scc1 lcp_48
lcd_47:
    s_getreg_b32 s62, hwreg(HW_REG_XCC_ID, 0, 4)
    v_cmp_ne_u32 vcc, s62, v117
    v_cmp_ne_u32 s[62:63], s56, v116
    s_mov_b64 exec, -1
    s_nop 2
    s_or_b64 vcc, vcc, s[62:63]
    s_cmp_eq_u64 vcc, 0
    s_cselect_b32 s69, 1, 0
    s_add_u32 s75, s73, 12288
    buffer_load_dwordx4 v[176:179], v1, s[8:11], s75 offen offset:0 sc1
    v_exp_f32 v28, v28
    v_cvt_pk_bf16_f32 v57, v26, v27
    v_exp_f32 v29, v29
    v_exp_f32 v30, v30
    v_exp_f32 v31, v31
    v_cvt_pk_bf16_f32 v58, v28, v29
    v_exp_f32 v32, v32
    v_cvt_pk_bf16_f32 v59, v30, v31
    v_exp_f32 v33, v33
    v_exp_f32 v34, v34
    v_exp_f32 v35, v35
    v_mfma_f32_32x32x16_bf16 v[8:23], v[72:75], v[56:59], v[8:23]
    v_cvt_pk_bf16_f32 v60, v32, v33
    v_exp_f32 v36, v36
    v_cvt_pk_bf16_f32 v61, v34, v35
    v_exp_f32 v37, v37
    v_exp_f32 v38, v38
    v_exp_f32 v39, v39
    v_cvt_pk_bf16_f32 v62, v36, v37
    v_cvt_pk_bf16_f32 v63, v38, v39
    s_waitcnt lgkmcnt(0)
    v_mfma_f32_32x32x16_bf16 v[24:39], v[68:71], v[4:7], 0
    ds_read_b128 v[64:67], v88 offset:4096
    v_exp_f32 v40, v40
    v_exp_f32 v41, v41
    v_exp_f32 v42, v42
    v_exp_f32 v43, v43
    v_cvt_pk_bf16_f32 v56, v40, v41
    v_mfma_f32_32x32x16_bf16 v[8:23], v[80:83], v[60:63], v[8:23]
    s_add_u32 s75, s73, 12288
    buffer_load_dwordx4 v[180:183], v1, s[8:11], s75 offen offset:1024 sc1
    v_exp_f32 v44, v44
    v_cvt_pk_bf16_f32 v57, v42, v43
    v_exp_f32 v45, v45
    v_exp_f32 v46, v46
    v_exp_f32 v47, v47
    v_cvt_pk_bf16_f32 v58, v44, v45
    v_exp_f32 v48, v48
    v_cvt_pk_bf16_f32 v59, v46, v47
    v_exp_f32 v49, v49
    v_exp_f32 v50, v50
    v_exp_f32 v51, v51
    v_mfma_f32_32x32x16_bf16 v[96:111], v[72:75], v[56:59], v[96:111]
    v_cvt_pk_bf16_f32 v60, v48, v49
    v_exp_f32 v52, v52
    v_cvt_pk_bf16_f32 v61, v50, v51
    v_exp_f32 v53, v53
    v_exp_f32 v54, v54
    v_exp_f32 v55, v55
    v_cvt_pk_bf16_f32 v62, v52, v53
    v_cvt_pk_bf16_f32 v63, v54, v55
    s_waitcnt lgkmcnt(0)
    v_mfma_f32_32x32x16_bf16 v[40:55], v[68:71], v[92:95], 0
    v_exp_f32 v24, v24
    v_exp_f32 v25, v25
    v_exp_f32 v26, v26
    v_exp_f32 v27, v27
    v_cvt_pk_bf16_f32 v56, v24, v25
    v_mfma_f32_32x32x16_bf16 v[96:111], v[80:83], v[60:63], v[96:111]
    s_mov_b64 exec, s[70:71]
    ds_read_b128 v[72:75], v89 offset:4096
    ds_read_b128 v[80:83], v89 offset:4608
    s_mov_b64 exec, -1
    s_add_u32 s75, s73, 12288
    buffer_load_dwordx4 v[184:187], v1, s[8:11], s75 offen offset:2048 sc1
    s_add_u32 s75, s73, 12288
    buffer_load_dwordx4 v[188:191], v1, s[8:11], s75 offen offset:3072 sc1
    v_exp_f32 v28, v28
    v_cvt_pk_bf16_f32 v57, v26, v27
    v_exp_f32 v29, v29
    v_exp_f32 v30, v30
    v_exp_f32 v31, v31
    v_cvt_pk_bf16_f32 v58, v28, v29
    v_exp_f32 v32, v32
    v_cvt_pk_bf16_f32 v59, v30, v31
    v_exp_f32 v33, v33
    v_exp_f32 v34, v34
    v_exp_f32 v35, v35
    v_mfma_f32_32x32x16_bf16 v[8:23], v[76:79], v[56:59], v[8:23]
    v_cvt_pk_bf16_f32 v60, v32, v33
    v_exp_f32 v36, v36
    v_cvt_pk_bf16_f32 v61, v34, v35
    v_exp_f32 v37, v37
    v_exp_f32 v38, v38
    v_exp_f32 v39, v39
    v_cvt_pk_bf16_f32 v62, v36, v37
    v_cvt_pk_bf16_f32 v63, v38, v39
    s_waitcnt lgkmcnt(0)
    v_mfma_f32_32x32x16_bf16 v[24:39], v[64:67], v[4:7], 0
    ds_read_b128 v[68:71], v88 offset:5120
    v_exp_f32 v40, v40
    v_exp_f32 v41, v41
    v_exp_f32 v42, v42
    v_exp_f32 v43, v43
    v_cvt_pk_bf16_f32 v56, v40, v41
    v_mfma_f32_32x32x16_bf16 v[8:23], v[84:87], v[60:63], v[8:23]
    s_add_u32 s75, s73, 16384
    buffer_load_dwordx4 v[192:195], v1, s[8:11], s75 offen offset:0 sc1
    v_exp_f32 v44, v44
    v_cvt_pk_bf16_f32 v57, v42, v43
    v_exp_f32 v45, v45
    v_exp_f32 v46, v46
    v_exp_f32 v47, v47
    v_cvt_pk_bf16_f32 v58, v44, v45
    v_exp_f32 v48, v48
    v_cvt_pk_bf16_f32 v59, v46, v47
    v_exp_f32 v49, v49
    v_exp_f32 v50, v50
    v_exp_f32 v51, v51
    v_mfma_f32_32x32x16_bf16 v[96:111], v[76:79], v[56:59], v[96:111]
    v_cvt_pk_bf16_f32 v60, v48, v49
    v_exp_f32 v52, v52
    v_cvt_pk_bf16_f32 v61, v50, v51
    v_exp_f32 v53, v53
    v_exp_f32 v54, v54
    v_exp_f32 v55, v55
    v_cvt_pk_bf16_f32 v62, v52, v53
    v_cvt_pk_bf16_f32 v63, v54, v55
    s_barrier
    s_waitcnt lgkmcnt(0)
    v_mfma_f32_32x32x16_bf16 v[40:55], v[64:67], v[92:95], 0
    v_exp_f32 v24, v24
    v_exp_f32 v25, v25
    v_exp_f32 v26, v26
    v_exp_f32 v27, v27
    v_cvt_pk_bf16_f32 v56, v24, v25
    v_mfma_f32_32x32x16_bf16 v[96:111], v[84:87], v[60:63], v[96:111]
    s_mov_b64 exec, s[70:71]
    ds_read_b128 v[76:79], v89 offset:5120
    ds_read_b128 v[84:87], v89 offset:5632
    s_mov_b64 exec, -1
    s_add_u32 s75, s73, 16384
    buffer_load_dwordx4 v[196:199], v1, s[8:11], s75 offen offset:1024 sc1
    v_exp_f32 v28, v28
    v_cvt_pk_bf16_f32 v57, v26, v27
    v_exp_f32 v29, v29
    v_exp_f32 v30, v30
    v_exp_f32 v31, v31
    v_cvt_pk_bf16_f32 v58, v28, v29
    v_exp_f32 v32, v32
    v_cvt_pk_bf16_f32 v59, v30, v31
    v_exp_f32 v33, v33
    v_exp_f32 v34, v34
    v_exp_f32 v35, v35
    v_mfma_f32_32x32x16_bf16 v[8:23], v[72:75], v[56:59], v[8:23]
    v_cvt_pk_bf16_f32 v60, v32, v33
    v_exp_f32 v36, v36
    v_cvt_pk_bf16_f32 v61, v34, v35
    v_exp_f32 v37, v37
    v_exp_f32 v38, v38
    v_exp_f32 v39, v39
    v_cvt_pk_bf16_f32 v62, v36, v37
    v_cvt_pk_bf16_f32 v63, v38, v39
    s_waitcnt lgkmcnt(0)
    v_mfma_f32_32x32x16_bf16 v[24:39], v[68:71], v[4:7], 0
    ds_read_b128 v[64:67], v88 offset:6144
    v_exp_f32 v40, v40
    v_exp_f32 v41, v41
    v_exp_f32 v42, v42
    v_exp_f32 v43, v43
    v_cvt_pk_bf16_f32 v56, v40, v41
    v_mfma_f32_32x32x16_bf16 v[8:23], v[80:83], v[60:63], v[8:23]
    s_add_u32 s75, s73, 16384
    buffer_load_dwordx4 v[200:203], v1, s[8:11], s75 offen offset:2048 sc1
    s_add_u32 s75, s73, 16384
    buffer_load_dwordx4 v[204:207], v1, s[8:11], s75 offen offset:3072 sc1
    v_exp_f32 v44, v44
    v_cvt_pk_bf16_f32 v57, v42, v43
    v_exp_f32 v45, v45
    v_exp_f32 v46, v46
    v_exp_f32 v47, v47
    v_cvt_pk_bf16_f32 v58, v44, v45
    v_exp_f32 v48, v48
    v_cvt_pk_bf16_f32 v59, v46, v47
    v_exp_f32 v49, v49
    v_exp_f32 v50, v50
    v_exp_f32 v51, v51
    v_mfma_f32_32x32x16_bf16 v[96:111], v[72:75], v[56:59], v[96:111]
    v_cvt_pk_bf16_f32 v60, v48, v49
    v_exp_f32 v52, v52
    v_cvt_pk_bf16_f32 v61, v50, v51
    v_exp_f32 v53, v53
    v_exp_f32 v54, v54
    v_exp_f32 v55, v55
    v_cvt_pk_bf16_f32 v62, v52, v53
    v_cvt_pk_bf16_f32 v63, v54, v55
    s_waitcnt lgkmcnt(0)
    v_mfma_f32_32x32x16_bf16 v[40:55], v[68:71], v[92:95], 0
    v_exp_f32 v24, v24
    v_exp_f32 v25, v25
    v_exp_f32 v26, v26
    v_exp_f32 v27, v27
    v_cvt_pk_bf16_f32 v56, v24, v25
    v_mfma_f32_32x32x16_bf16 v[96:111], v[80:83], v[60:63], v[96:111]
    s_mov_b64 exec, s[70:71]
    ds_read_b128 v[72:75], v89 offset:6144
    ds_read_b128 v[80:83], v89 offset:6656
    s_mov_b64 exec, -1
    s_add_u32 s75, s73, 20480
    buffer_load_dwordx4 v[208:211], v1, s[8:11], s75 offen offset:0 sc1
    v_exp_f32 v28, v28
    v_cvt_pk_bf16_f32 v57, v26, v27
    v_exp_f32 v29, v29
    v_exp_f32 v30, v30
    v_exp_f32 v31, v31
    v_cvt_pk_bf16_f32 v58, v28, v29
    v_exp_f32 v32, v32
    v_cvt_pk_bf16_f32 v59, v30, v31
    v_exp_f32 v33, v33
    v_exp_f32 v34, v34
    v_exp_f32 v35, v35
    v_mfma_f32_32x32x16_bf16 v[8:23], v[76:79], v[56:59], v[8:23]
    v_cvt_pk_bf16_f32 v60, v32, v33
    v_exp_f32 v36, v36
    v_cvt_pk_bf16_f32 v61, v34, v35
    v_exp_f32 v37, v37
    v_exp_f32 v38, v38
    v_exp_f32 v39, v39
    v_cvt_pk_bf16_f32 v62, v36, v37
    v_cvt_pk_bf16_f32 v63, v38, v39
    s_waitcnt lgkmcnt(0)
    v_mfma_f32_32x32x16_bf16 v[24:39], v[64:67], v[4:7], 0
    ds_read_b128 v[68:71], v88 offset:7168
    v_exp_f32 v40, v40
    v_exp_f32 v41, v41
    v_exp_f32 v42, v42
    v_exp_f32 v43, v43
    v_cvt_pk_bf16_f32 v56, v40, v41
    v_mfma_f32_32x32x16_bf16 v[8:23], v[84:87], v[60:63], v[8:23]
    s_add_u32 s75, s73, 20480
    buffer_load_dwordx4 v[212:215], v1, s[8:11], s75 offen offset:1024 sc1
    s_add_u32 s75, s73, 20480
    buffer_load_dwordx4 v[216:219], v1, s[8:11], s75 offen offset:2048 sc1
    v_exp_f32 v44, v44
    v_cvt_pk_bf16_f32 v57, v42, v43
    v_exp_f32 v45, v45
    v_exp_f32 v46, v46
    v_exp_f32 v47, v47
    v_cvt_pk_bf16_f32 v58, v44, v45
    v_exp_f32 v48, v48
    v_cvt_pk_bf16_f32 v59, v46, v47
    v_exp_f32 v49, v49
    v_exp_f32 v50, v50
    v_exp_f32 v51, v51
    v_mfma_f32_32x32x16_bf16 v[96:111], v[76:79], v[56:59], v[96:111]
    v_cvt_pk_bf16_f32 v60, v48, v49
    v_exp_f32 v52, v52
    v_cvt_pk_bf16_f32 v61, v50, v51
    v_exp_f32 v53, v53
    v_exp_f32 v54, v54
    v_exp_f32 v55, v55
    v_cvt_pk_bf16_f32 v62, v52, v53
    v_cvt_pk_bf16_f32 v63, v54, v55
    s_waitcnt lgkmcnt(0)
    v_mfma_f32_32x32x16_bf16 v[40:55], v[64:67], v[92:95], 0
    v_exp_f32 v24, v24
    v_exp_f32 v25, v25
    v_exp_f32 v26, v26
    v_exp_f32 v27, v27
    v_cvt_pk_bf16_f32 v56, v24, v25
    v_mfma_f32_32x32x16_bf16 v[96:111], v[84:87], v[60:63], v[96:111]
    s_mov_b64 exec, s[70:71]
    ds_read_b128 v[76:79], v89 offset:7168
    ds_read_b128 v[84:87], v89 offset:7680
    s_mov_b64 exec, -1
    s_add_u32 s75, s73, 20480
    buffer_load_dwordx4 v[220:223], v1, s[8:11], s75 offen offset:3072 sc1
    v_exp_f32 v28, v28
    v_cvt_pk_bf16_f32 v57, v26, v27
    v_exp_f32 v29, v29
    v_exp_f32 v30, v30
    v_exp_f32 v31, v31
    v_cvt_pk_bf16_f32 v58, v28, v29
    v_exp_f32 v32, v32
    v_cvt_pk_bf16_f32 v59, v30, v31
    v_exp_f32 v33, v33
    v_exp_f32 v34, v34
    v_exp_f32 v35, v35
    v_mfma_f32_32x32x16_bf16 v[8:23], v[72:75], v[56:59], v[8:23]
    v_cvt_pk_bf16_f32 v60, v32, v33
    v_exp_f32 v36, v36
    v_cvt_pk_bf16_f32 v61, v34, v35
    v_exp_f32 v37, v37
    v_exp_f32 v38, v38
    v_exp_f32 v39, v39
    v_cvt_pk_bf16_f32 v62, v36, v37
    v_cvt_pk_bf16_f32 v63, v38, v39
    s_waitcnt lgkmcnt(0)
    v_mfma_f32_32x32x16_bf16 v[24:39], v[68:71], v[4:7], 0
    ds_read_b128 v[64:67], v88 offset:8192
    v_exp_f32 v40, v40
    v_exp_f32 v41, v41
    v_exp_f32 v42, v42
    v_exp_f32 v43, v43
    v_cvt_pk_bf16_f32 v56, v40, v41
    v_mfma_f32_32x32x16_bf16 v[8:23], v[80:83], v[60:63], v[8:23]
    s_add_u32 s75, s73, 24576
    buffer_load_dwordx4 v[224:227], v1, s[8:11], s75 offen offset:0 sc1
    v_exp_f32 v44, v44
    v_cvt_pk_bf16_f32 v57, v42, v43
    v_exp_f32 v45, v45
    v_exp_f32 v46, v46
    v_exp_f32 v47, v47
    v_cvt_pk_bf16_f32 v58, v44, v45
    v_exp_f32 v48, v48
    v_cvt_pk_bf16_f32 v59, v46, v47
    v_exp_f32 v49, v49
    v_exp_f32 v50, v50
    v_exp_f32 v51, v51
    v_mfma_f32_32x32x16_bf16 v[96:111], v[72:75], v[56:59], v[96:111]
    v_cvt_pk_bf16_f32 v60, v48, v49
    v_exp_f32 v52, v52
    v_cvt_pk_bf16_f32 v61, v50, v51
    v_exp_f32 v53, v53
    v_exp_f32 v54, v54
    v_exp_f32 v55, v55
    v_cvt_pk_bf16_f32 v62, v52, v53
    v_cvt_pk_bf16_f32 v63, v54, v55
    s_waitcnt lgkmcnt(0)
    v_mfma_f32_32x32x16_bf16 v[40:55], v[68:71], v[92:95], 0
    v_exp_f32 v24, v24
    v_exp_f32 v25, v25
    v_exp_f32 v26, v26
    v_exp_f32 v27, v27
    v_cvt_pk_bf16_f32 v56, v24, v25
    v_mfma_f32_32x32x16_bf16 v[96:111], v[80:83], v[60:63], v[96:111]
    s_mov_b64 exec, s[70:71]
    ds_read_b128 v[72:75], v89 offset:8192
    ds_read_b128 v[80:83], v89 offset:8704
    s_mov_b64 exec, -1
    s_add_u32 s75, s73, 24576
    buffer_load_dwordx4 v[228:231], v1, s[8:11], s75 offen offset:1024 sc1
    s_add_u32 s75, s73, 24576
    buffer_load_dwordx4 v[232:235], v1, s[8:11], s75 offen offset:2048 sc1
    v_exp_f32 v28, v28
    v_cvt_pk_bf16_f32 v57, v26, v27
    v_exp_f32 v29, v29
    v_exp_f32 v30, v30
    v_exp_f32 v31, v31
    v_cvt_pk_bf16_f32 v58, v28, v29
    v_exp_f32 v32, v32
    v_cvt_pk_bf16_f32 v59, v30, v31
    v_exp_f32 v33, v33
    v_exp_f32 v34, v34
    v_exp_f32 v35, v35
    v_mfma_f32_32x32x16_bf16 v[8:23], v[76:79], v[56:59], v[8:23]
    v_cvt_pk_bf16_f32 v60, v32, v33
    v_exp_f32 v36, v36
    v_cvt_pk_bf16_f32 v61, v34, v35
    v_exp_f32 v37, v37
    v_exp_f32 v38, v38
    v_exp_f32 v39, v39
    v_cvt_pk_bf16_f32 v62, v36, v37
    v_cvt_pk_bf16_f32 v63, v38, v39
    s_waitcnt lgkmcnt(0)
    v_mfma_f32_32x32x16_bf16 v[24:39], v[64:67], v[4:7], 0
    ds_read_b128 v[68:71], v88 offset:9216
    v_exp_f32 v40, v40
    v_exp_f32 v41, v41
    v_exp_f32 v42, v42
    v_exp_f32 v43, v43
    v_cvt_pk_bf16_f32 v56, v40, v41
    v_mfma_f32_32x32x16_bf16 v[8:23], v[84:87], v[60:63], v[8:23]
    s_add_u32 s75, s73, 24576
    buffer_load_dwordx4 v[236:239], v1, s[8:11], s75 offen offset:3072 sc1
    v_exp_f32 v44, v44
    v_cvt_pk_bf16_f32 v57, v42, v43
    v_exp_f32 v45, v45
    v_exp_f32 v46, v46
    v_exp_f32 v47, v47
    v_cvt_pk_bf16_f32 v58, v44, v45
    v_exp_f32 v48, v48
    v_cvt_pk_bf16_f32 v59, v46, v47
    v_exp_f32 v49, v49
    v_exp_f32 v50, v50
    v_exp_f32 v51, v51
    v_mfma_f32_32x32x16_bf16 v[96:111], v[76:79], v[56:59], v[96:111]
    v_cvt_pk_bf16_f32 v60, v48, v49
    v_exp_f32 v52, v52
    v_cvt_pk_bf16_f32 v61, v50, v51
    v_exp_f32 v53, v53
    v_exp_f32 v54, v54
    v_exp_f32 v55, v55
    v_cvt_pk_bf16_f32 v62, v52, v53
    v_cvt_pk_bf16_f32 v63, v54, v55
    v_add_u32 v88, 8192, v88
    v_add_u32 v89, 8192, v89
    s_barrier
    s_waitcnt lgkmcnt(0)
    v_mfma_f32_32x32x16_bf16 v[40:55], v[64:67], v[92:95], 0
    v_exp_f32 v24, v24
    v_exp_f32 v25, v25
    v_exp_f32 v26, v26
    v_exp_f32 v27, v27
    v_cvt_pk_bf16_f32 v56, v24, v25
    v_mfma_f32_32x32x16_bf16 v[96:111], v[84:87], v[60:63], v[96:111]
    s_mov_b64 exec, s[70:71]
    ds_read_b128 v[76:79], v89 offset:1024
    ds_read_b128 v[84:87], v89 offset:1536
    s_mov_b64 exec, -1
    s_add_u32 s75, s73, 28672
    buffer_load_dwordx4 v[240:243], v1, s[8:11], s75 offen offset:0 sc1
    s_add_u32 s75, s73, 28672
    buffer_load_dwordx4 v[244:247], v1, s[8:11], s75 offen offset:1024 sc1
    v_exp_f32 v28, v28
    v_cvt_pk_bf16_f32 v57, v26, v27
    v_exp_f32 v29, v29
    v_exp_f32 v30, v30
    v_exp_f32 v31, v31
    v_cvt_pk_bf16_f32 v58, v28, v29
    v_exp_f32 v32, v32
    v_cvt_pk_bf16_f32 v59, v30, v31
    v_exp_f32 v33, v33
    v_exp_f32 v34, v34
    v_exp_f32 v35, v35
    v_mfma_f32_32x32x16_bf16 v[8:23], v[72:75], v[56:59], v[8:23]
    v_cvt_pk_bf16_f32 v60, v32, v33
    v_exp_f32 v36, v36
    v_cvt_pk_bf16_f32 v61, v34, v35
    v_exp_f32 v37, v37
    v_exp_f32 v38, v38
    v_exp_f32 v39, v39
    v_cvt_pk_bf16_f32 v62, v36, v37
    v_cvt_pk_bf16_f32 v63, v38, v39
    s_waitcnt lgkmcnt(0)
    v_mfma_f32_32x32x16_bf16 v[24:39], v[68:71], v[4:7], 0
    ds_read_b128 v[64:67], v88 offset:2048
    v_exp_f32 v40, v40
    v_exp_f32 v41, v41
    v_exp_f32 v42, v42
    v_exp_f32 v43, v43
    v_cvt_pk_bf16_f32 v56, v40, v41
    v_mfma_f32_32x32x16_bf16 v[8:23], v[80:83], v[60:63], v[8:23]
    s_add_u32 s75, s73, 28672
    buffer_load_dwordx4 v[248:251], v1, s[8:11], s75 offen offset:2048 sc1
    v_exp_f32 v44, v44
    v_cvt_pk_bf16_f32 v57, v42, v43
    v_exp_f32 v45, v45
    v_exp_f32 v46, v46
    v_exp_f32 v47, v47
    v_cvt_pk_bf16_f32 v58, v44, v45
    v_exp_f32 v48, v48
    v_cvt_pk_bf16_f32 v59, v46, v47
    v_exp_f32 v49, v49
    v_exp_f32 v50, v50
    v_exp_f32 v51, v51
    v_mfma_f32_32x32x16_bf16 v[96:111], v[72:75], v[56:59], v[96:111]
    v_cvt_pk_bf16_f32 v60, v48, v49
    v_exp_f32 v52, v52
    v_cvt_pk_bf16_f32 v61, v50, v51
    v_exp_f32 v53, v53
    v_exp_f32 v54, v54
    v_exp_f32 v55, v55
    v_cvt_pk_bf16_f32 v62, v52, v53
    v_cvt_pk_bf16_f32 v63, v54, v55
    s_waitcnt lgkmcnt(0)
    v_mfma_f32_32x32x16_bf16 v[40:55], v[68:71], v[92:95], 0
    v_exp_f32 v24, v24
    v_exp_f32 v25, v25
    v_exp_f32 v26, v26
    v_exp_f32 v27, v27
    v_cvt_pk_bf16_f32 v56, v24, v25
    v_mfma_f32_32x32x16_bf16 v[96:111], v[80:83], v[60:63], v[96:111]
    s_mov_b64 exec, s[70:71]
    ds_read_b128 v[72:75], v89 offset:2048
    ds_read_b128 v[80:83], v89 offset:2560
    s_mov_b64 exec, -1
    s_add_u32 s75, s73, 28672
    buffer_load_dwordx4 v[252:255], v1, s[8:11], s75 offen offset:3072 sc1
    v_exp_f32 v28, v28
    v_cvt_pk_bf16_f32 v57, v26, v27
    v_exp_f32 v29, v29
    v_exp_f32 v30, v30
    v_exp_f32 v31, v31
    v_cvt_pk_bf16_f32 v58, v28, v29
    v_exp_f32 v32, v32
    v_cvt_pk_bf16_f32 v59, v30, v31
    v_exp_f32 v33, v33
    v_exp_f32 v34, v34
    v_exp_f32 v35, v35
    v_mfma_f32_32x32x16_bf16 v[8:23], v[76:79], v[56:59], v[8:23]
    v_cvt_pk_bf16_f32 v60, v32, v33
    v_exp_f32 v36, v36
    v_cvt_pk_bf16_f32 v61, v34, v35
    v_exp_f32 v37, v37
    v_exp_f32 v38, v38
    v_exp_f32 v39, v39
    v_cvt_pk_bf16_f32 v62, v36, v37
    v_cvt_pk_bf16_f32 v63, v38, v39
    s_waitcnt lgkmcnt(0)
    v_mfma_f32_32x32x16_bf16 v[24:39], v[64:67], v[4:7], 0
    ds_read_b128 v[68:71], v88 offset:3072
    v_exp_f32 v40, v40
    v_exp_f32 v41, v41
    v_exp_f32 v42, v42
    v_exp_f32 v43, v43
    v_cvt_pk_bf16_f32 v56, v40, v41
    v_mfma_f32_32x32x16_bf16 v[8:23], v[84:87], v[60:63], v[8:23]
    s_add_u32 s75, s68, 0
    buffer_load_dwordx4 v[112:115], v1, s[8:11], s75 offen offset:0 sc1
    s_add_u32 s75, s68, 0
    buffer_load_dwordx4 v[116:119], v1, s[8:11], s75 offen offset:1024 sc1
    v_exp_f32 v44, v44
    v_cvt_pk_bf16_f32 v57, v42, v43
    v_exp_f32 v45, v45
    v_exp_f32 v46, v46
    v_exp_f32 v47, v47
    v_cvt_pk_bf16_f32 v58, v44, v45
    v_exp_f32 v48, v48
    v_cvt_pk_bf16_f32 v59, v46, v47
    v_exp_f32 v49, v49
    v_exp_f32 v50, v50
    v_exp_f32 v51, v51
    v_mfma_f32_32x32x16_bf16 v[96:111], v[76:79], v[56:59], v[96:111]
    v_cvt_pk_bf16_f32 v60, v48, v49
    v_exp_f32 v52, v52
    v_cvt_pk_bf16_f32 v61, v50, v51
    v_exp_f32 v53, v53
    v_exp_f32 v54, v54
    v_exp_f32 v55, v55
    v_cvt_pk_bf16_f32 v62, v52, v53
    v_cvt_pk_bf16_f32 v63, v54, v55
    s_waitcnt lgkmcnt(0)
    v_mfma_f32_32x32x16_bf16 v[40:55], v[64:67], v[92:95], 0
    v_exp_f32 v24, v24
    v_exp_f32 v25, v25
    v_exp_f32 v26, v26
    v_exp_f32 v27, v27
    v_cvt_pk_bf16_f32 v56, v24, v25
    v_mfma_f32_32x32x16_bf16 v[96:111], v[84:87], v[60:63], v[96:111]
    s_mov_b64 exec, s[70:71]
    ds_read_b128 v[76:79], v89 offset:3072
    ds_read_b128 v[84:87], v89 offset:3584
    s_mov_b64 exec, -1
    s_add_u32 s75, s68, 0
    buffer_load_dwordx4 v[120:123], v1, s[8:11], s75 offen offset:2048 sc1
    v_exp_f32 v28, v28
    v_cvt_pk_bf16_f32 v57, v26, v27
    v_exp_f32 v29, v29
    v_exp_f32 v30, v30
    v_exp_f32 v31, v31
    v_cvt_pk_bf16_f32 v58, v28, v29
    v_exp_f32 v32, v32
    v_cvt_pk_bf16_f32 v59, v30, v31
    v_exp_f32 v33, v33
    v_exp_f32 v34, v34
    v_exp_f32 v35, v35
    v_mfma_f32_32x32x16_bf16 v[8:23], v[72:75], v[56:59], v[8:23]
    v_cvt_pk_bf16_f32 v60, v32, v33
    v_exp_f32 v36, v36
    v_cvt_pk_bf16_f32 v61, v34, v35
    v_exp_f32 v37, v37
    v_exp_f32 v38, v38
    v_exp_f32 v39, v39
    v_cvt_pk_bf16_f32 v62, v36, v37
    v_cvt_pk_bf16_f32 v63, v38, v39
    s_waitcnt lgkmcnt(0)
    v_mfma_f32_32x32x16_bf16 v[24:39], v[68:71], v[4:7], 0
    ds_read_b128 v[64:67], v88 offset:4096
    v_exp_f32 v40, v40
    v_exp_f32 v41, v41
    v_exp_f32 v42, v42
    v_exp_f32 v43, v43
    v_cvt_pk_bf16_f32 v56, v40, v41
    v_mfma_f32_32x32x16_bf16 v[8:23], v[80:83], v[60:63], v[8:23]
    s_add_u32 s75, s68, 0
    buffer_load_dwordx4 v[124:127], v1, s[8:11], s75 offen offset:3072 sc1
    v_exp_f32 v44, v44
    v_cvt_pk_bf16_f32 v57, v42, v43
    v_exp_f32 v45, v45
    v_exp_f32 v46, v46
    v_exp_f32 v47, v47
    v_cvt_pk_bf16_f32 v58, v44, v45
    v_exp_f32 v48, v48
    v_cvt_pk_bf16_f32 v59, v46, v47
    v_exp_f32 v49, v49
    v_exp_f32 v50, v50
    v_exp_f32 v51, v51
    v_mfma_f32_32x32x16_bf16 v[96:111], v[72:75], v[56:59], v[96:111]
    v_cvt_pk_bf16_f32 v60, v48, v49
    v_exp_f32 v52, v52
    v_cvt_pk_bf16_f32 v61, v50, v51
    v_exp_f32 v53, v53
    v_exp_f32 v54, v54
    v_exp_f32 v55, v55
    v_cvt_pk_bf16_f32 v62, v52, v53
    v_cvt_pk_bf16_f32 v63, v54, v55
    s_waitcnt lgkmcnt(0)
    v_mfma_f32_32x32x16_bf16 v[40:55], v[68:71], v[92:95], 0
    v_exp_f32 v24, v24
    v_exp_f32 v25, v25
    v_exp_f32 v26, v26
    v_exp_f32 v27, v27
    v_cvt_pk_bf16_f32 v56, v24, v25
    v_mfma_f32_32x32x16_bf16 v[96:111], v[80:83], v[60:63], v[96:111]
    s_mov_b64 exec, s[70:71]
    ds_read_b128 v[72:75], v89 offset:4096
    ds_read_b128 v[80:83], v89 offset:4608
    s_mov_b64 exec, -1
    s_add_u32 s75, s68, 4096
    buffer_load_dwordx4 v[128:131], v1, s[8:11], s75 offen offset:0 sc1
    s_add_u32 s75, s68, 4096
    buffer_load_dwordx4 v[132:135], v1, s[8:11], s75 offen offset:1024 sc1
    v_exp_f32 v28, v28
    v_cvt_pk_bf16_f32 v57, v26, v27
    v_exp_f32 v29, v29
    v_exp_f32 v30, v30
    v_exp_f32 v31, v31
    v_cvt_pk_bf16_f32 v58, v28, v29
    v_exp_f32 v32, v32
    v_cvt_pk_bf16_f32 v59, v30, v31
    v_exp_f32 v33, v33
    v_exp_f32 v34, v34
    v_exp_f32 v35, v35
    v_mfma_f32_32x32x16_bf16 v[8:23], v[76:79], v[56:59], v[8:23]
    v_cvt_pk_bf16_f32 v60, v32, v33
    v_exp_f32 v36, v36
    v_cvt_pk_bf16_f32 v61, v34, v35
    v_exp_f32 v37, v37
    v_exp_f32 v38, v38
    v_exp_f32 v39, v39
    v_cvt_pk_bf16_f32 v62, v36, v37
    v_cvt_pk_bf16_f32 v63, v38, v39
    s_waitcnt lgkmcnt(0)
    v_mfma_f32_32x32x16_bf16 v[24:39], v[64:67], v[4:7], 0
    ds_read_b128 v[68:71], v88 offset:5120
    v_exp_f32 v40, v40
    v_exp_f32 v41, v41
    v_exp_f32 v42, v42
    v_exp_f32 v43, v43
    v_cvt_pk_bf16_f32 v56, v40, v41
    v_mfma_f32_32x32x16_bf16 v[8:23], v[84:87], v[60:63], v[8:23]
    s_add_u32 s75, s68, 4096
    buffer_load_dwordx4 v[136:139], v1, s[8:11], s75 offen offset:2048 sc1
    v_exp_f32 v44, v44
    v_cvt_pk_bf16_f32 v57, v42, v43
    v_exp_f32 v45, v45
    v_exp_f32 v46, v46
    v_exp_f32 v47, v47
    v_cvt_pk_bf16_f32 v58, v44, v45
    v_exp_f32 v48, v48
    v_cvt_pk_bf16_f32 v59, v46, v47
    v_exp_f32 v49, v49
    v_exp_f32 v50, v50
    v_exp_f32 v51, v51
    v_mfma_f32_32x32x16_bf16 v[96:111], v[76:79], v[56:59], v[96:111]
    v_cvt_pk_bf16_f32 v60, v48, v49
    v_exp_f32 v52, v52
    v_cvt_pk_bf16_f32 v61, v50, v51
    v_exp_f32 v53, v53
    v_exp_f32 v54, v54
    v_exp_f32 v55, v55
    v_cvt_pk_bf16_f32 v62, v52, v53
    v_cvt_pk_bf16_f32 v63, v54, v55
    s_barrier
    s_waitcnt lgkmcnt(0)
    v_mfma_f32_32x32x16_bf16 v[40:55], v[64:67], v[92:95], 0
    v_exp_f32 v24, v24
    v_exp_f32 v25, v25
    v_exp_f32 v26, v26
    v_exp_f32 v27, v27
    v_cvt_pk_bf16_f32 v56, v24, v25
    v_mfma_f32_32x32x16_bf16 v[96:111], v[84:87], v[60:63], v[96:111]
    s_mov_b64 exec, s[70:71]
    ds_read_b128 v[76:79], v89 offset:5120
    ds_read_b128 v[84:87], v89 offset:5632
    s_mov_b64 exec, -1
    s_add_u32 s75, s68, 4096
    buffer_load_dwordx4 v[140:143], v1, s[8:11], s75 offen offset:3072 sc1
    s_add_u32 s75, s68, 8192
    buffer_load_dwordx4 v[144:147], v1, s[8:11], s75 offen offset:0 sc1
    v_exp_f32 v28, v28
    v_cvt_pk_bf16_f32 v57, v26, v27
    v_exp_f32 v29, v29
    v_exp_f32 v30, v30
    v_exp_f32 v31, v31
    v_cvt_pk_bf16_f32 v58, v28, v29
    v_exp_f32 v32, v32
    v_cvt_pk_bf16_f32 v59, v30, v31
    v_exp_f32 v33, v33
    v_exp_f32 v34, v34
    v_exp_f32 v35, v35
    v_mfma_f32_32x32x16_bf16 v[8:23], v[72:75], v[56:59], v[8:23]
    v_cvt_pk_bf16_f32 v60, v32, v33
    v_exp_f32 v36, v36
    v_cvt_pk_bf16_f32 v61, v34, v35
    v_exp_f32 v37, v37
    v_exp_f32 v38, v38
    v_exp_f32 v39, v39
    v_cvt_pk_bf16_f32 v62, v36, v37
    v_cvt_pk_bf16_f32 v63, v38, v39
    s_waitcnt lgkmcnt(0)
    v_mfma_f32_32x32x16_bf16 v[24:39], v[68:71], v[4:7], 0
    ds_read_b128 v[64:67], v88 offset:6144
    v_exp_f32 v40, v40
    v_exp_f32 v41, v41
    v_exp_f32 v42, v42
    v_exp_f32 v43, v43
    v_cvt_pk_bf16_f32 v56, v40, v41
    v_mfma_f32_32x32x16_bf16 v[8:23], v[80:83], v[60:63], v[8:23]
    s_add_u32 s75, s68, 8192
    buffer_load_dwordx4 v[148:151], v1, s[8:11], s75 offen offset:1024 sc1
    v_exp_f32 v44, v44
    v_cvt_pk_bf16_f32 v57, v42, v43
    v_exp_f32 v45, v45
    v_exp_f32 v46, v46
    v_exp_f32 v47, v47
    v_cvt_pk_bf16_f32 v58, v44, v45
    v_exp_f32 v48, v48
    v_cvt_pk_bf16_f32 v59, v46, v47
    v_exp_f32 v49, v49
    v_exp_f32 v50, v50
    v_exp_f32 v51, v51
    v_mfma_f32_32x32x16_bf16 v[96:111], v[72:75], v[56:59], v[96:111]
    v_cvt_pk_bf16_f32 v60, v48, v49
    v_exp_f32 v52, v52
    v_cvt_pk_bf16_f32 v61, v50, v51
    v_exp_f32 v53, v53
    v_exp_f32 v54, v54
    v_exp_f32 v55, v55
    v_cvt_pk_bf16_f32 v62, v52, v53
    v_cvt_pk_bf16_f32 v63, v54, v55
    s_waitcnt lgkmcnt(0)
    v_mfma_f32_32x32x16_bf16 v[40:55], v[68:71], v[92:95], 0
    v_exp_f32 v24, v24
    v_exp_f32 v25, v25
    v_exp_f32 v26, v26
    v_exp_f32 v27, v27
    v_cvt_pk_bf16_f32 v56, v24, v25
    v_mfma_f32_32x32x16_bf16 v[96:111], v[80:83], v[60:63], v[96:111]
    s_mov_b64 exec, s[70:71]
    ds_read_b128 v[72:75], v89 offset:6144
    ds_read_b128 v[80:83], v89 offset:6656
    s_mov_b64 exec, -1
    s_add_u32 s75, s68, 8192
    buffer_load_dwordx4 v[152:155], v1, s[8:11], s75 offen offset:2048 sc1
    v_exp_f32 v28, v28
    v_cvt_pk_bf16_f32 v57, v26, v27
    v_exp_f32 v29, v29
    v_exp_f32 v30, v30
    v_exp_f32 v31, v31
    v_cvt_pk_bf16_f32 v58, v28, v29
    v_exp_f32 v32, v32
    v_cvt_pk_bf16_f32 v59, v30, v31
    v_exp_f32 v33, v33
    v_exp_f32 v34, v34
    v_exp_f32 v35, v35
    v_mfma_f32_32x32x16_bf16 v[8:23], v[76:79], v[56:59], v[8:23]
    v_cvt_pk_bf16_f32 v60, v32, v33
    v_exp_f32 v36, v36
    v_cvt_pk_bf16_f32 v61, v34, v35
    v_exp_f32 v37, v37
    v_exp_f32 v38, v38
    v_exp_f32 v39, v39
    v_cvt_pk_bf16_f32 v62, v36, v37
    v_cvt_pk_bf16_f32 v63, v38, v39
    s_waitcnt lgkmcnt(0)
    v_mfma_f32_32x32x16_bf16 v[24:39], v[64:67], v[4:7], 0
    ds_read_b128 v[68:71], v88 offset:7168
    v_exp_f32 v40, v40
    v_exp_f32 v41, v41
    v_exp_f32 v42, v42
    v_exp_f32 v43, v43
    v_cvt_pk_bf16_f32 v56, v40, v41
    v_mfma_f32_32x32x16_bf16 v[8:23], v[84:87], v[60:63], v[8:23]
    s_add_u32 s75, s68, 8192
    buffer_load_dwordx4 v[156:159], v1, s[8:11], s75 offen offset:3072 sc1
    s_add_u32 s75, s68, 12288
    buffer_load_dwordx4 v[160:163], v1, s[8:11], s75 offen offset:0 sc1
    v_exp_f32 v44, v44
    v_cvt_pk_bf16_f32 v57, v42, v43
    v_exp_f32 v45, v45
    v_exp_f32 v46, v46
    v_exp_f32 v47, v47
    v_cvt_pk_bf16_f32 v58, v44, v45
    v_exp_f32 v48, v48
    v_cvt_pk_bf16_f32 v59, v46, v47
    v_exp_f32 v49, v49
    v_exp_f32 v50, v50
    v_exp_f32 v51, v51
    v_mfma_f32_32x32x16_bf16 v[96:111], v[76:79], v[56:59], v[96:111]
    v_cvt_pk_bf16_f32 v60, v48, v49
    v_exp_f32 v52, v52
    v_cvt_pk_bf16_f32 v61, v50, v51
    v_exp_f32 v53, v53
    v_exp_f32 v54, v54
    v_exp_f32 v55, v55
    v_cvt_pk_bf16_f32 v62, v52, v53
    v_cvt_pk_bf16_f32 v63, v54, v55
    s_waitcnt lgkmcnt(0)
    v_mfma_f32_32x32x16_bf16 v[40:55], v[64:67], v[92:95], 0
    v_exp_f32 v24, v24
    v_exp_f32 v25, v25
    v_exp_f32 v26, v26
    v_exp_f32 v27, v27
    v_cvt_pk_bf16_f32 v56, v24, v25
    v_mfma_f32_32x32x16_bf16 v[96:111], v[84:87], v[60:63], v[96:111]
    s_mov_b64 exec, s[70:71]
    ds_read_b128 v[76:79], v89 offset:7168
    ds_read_b128 v[84:87], v89 offset:7680
    s_mov_b64 exec, -1
    s_add_u32 s75, s68, 12288
    buffer_load_dwordx4 v[164:167], v1, s[8:11], s75 offen offset:1024 sc1
    v_exp_f32 v28, v28
    v_cvt_pk_bf16_f32 v57, v26, v27
    v_exp_f32 v29, v29
    v_exp_f32 v30, v30
    v_exp_f32 v31, v31
    v_cvt_pk_bf16_f32 v58, v28, v29
    v_exp_f32 v32, v32
    v_cvt_pk_bf16_f32 v59, v30, v31
    v_exp_f32 v33, v33
    v_exp_f32 v34, v34
    v_exp_f32 v35, v35
    v_mfma_f32_32x32x16_bf16 v[8:23], v[72:75], v[56:59], v[8:23]
    v_cvt_pk_bf16_f32 v60, v32, v33
    v_exp_f32 v36, v36
    v_cvt_pk_bf16_f32 v61, v34, v35
    v_exp_f32 v37, v37
    v_exp_f32 v38, v38
    v_exp_f32 v39, v39
    v_cvt_pk_bf16_f32 v62, v36, v37
    v_cvt_pk_bf16_f32 v63, v38, v39
    s_waitcnt lgkmcnt(0)
    v_mfma_f32_32x32x16_bf16 v[24:39], v[68:71], v[4:7], 0
    ds_read_b128 v[64:67], v88 offset:8192
    v_exp_f32 v40, v40
    v_exp_f32 v41, v41
    v_exp_f32 v42, v42
    v_exp_f32 v43, v43
    v_cvt_pk_bf16_f32 v56, v40, v41
    v_mfma_f32_32x32x16_bf16 v[8:23], v[80:83], v[60:63], v[8:23]
    s_add_u32 s75, s68, 12288
    buffer_load_dwordx4 v[168:171], v1, s[8:11], s75 offen offset:2048 sc1
    s_add_u32 s75, s68, 12288
    buffer_load_dwordx4 v[172:175], v1, s[8:11], s75 offen offset:3072 sc1
    v_exp_f32 v44, v44
    v_cvt_pk_bf16_f32 v57, v42, v43
    v_exp_f32 v45, v45
    v_exp_f32 v46, v46
    v_exp_f32 v47, v47
    v_cvt_pk_bf16_f32 v58, v44, v45
    v_exp_f32 v48, v48
    v_cvt_pk_bf16_f32 v59, v46, v47
    v_exp_f32 v49, v49
    v_exp_f32 v50, v50
    v_exp_f32 v51, v51
    v_mfma_f32_32x32x16_bf16 v[96:111], v[72:75], v[56:59], v[96:111]
    v_cvt_pk_bf16_f32 v60, v48, v49
    v_exp_f32 v52, v52
    v_cvt_pk_bf16_f32 v61, v50, v51
    v_exp_f32 v53, v53
    v_exp_f32 v54, v54
    v_exp_f32 v55, v55
    v_cvt_pk_bf16_f32 v62, v52, v53
    v_cvt_pk_bf16_f32 v63, v54, v55
    s_waitcnt lgkmcnt(0)
    v_mfma_f32_32x32x16_bf16 v[40:55], v[68:71], v[92:95], 0
    v_exp_f32 v24, v24
    v_exp_f32 v25, v25
    v_exp_f32 v26, v26
    v_exp_f32 v27, v27
    v_cvt_pk_bf16_f32 v56, v24, v25
    v_mfma_f32_32x32x16_bf16 v[96:111], v[80:83], v[60:63], v[96:111]
    s_mov_b64 exec, s[70:71]
    ds_read_b128 v[72:75], v89 offset:8192
    ds_read_b128 v[80:83], v89 offset:8704
    s_mov_b64 exec, -1
    s_mov_b32 s12, s16
    s_mov_b32 s13, s17
    s_mov_b32 s14, 0x200000
    s_mov_b32 s15, 0x00020000
    v_and_b32 v2, 15, v0
    v_lshrrev_b32 v3, 4, v0
    v_lshlrev_b32 v2, 10, v2
    v_lshl_add_u32 v2, v3, 3, v2
    s_lshl_b32 s62, s7, 15
    s_lshl_b32 s63, s52, 8
    s_add_u32 s62, s62, s63
    s_lshl_b32 s63, s4, 5
    s_add_u32 s62, s62, s63
    buffer_load_dwordx2 v[4:5], v2, s[12:15], s62 offen
    s_add_u32 s62, s62, 16384
    buffer_load_dwordx2 v[6:7], v2, s[12:15], s62 offen
    v_exp_f32 v28, v28
    v_cvt_pk_bf16_f32 v57, v26, v27
    v_exp_f32 v29, v29
    v_exp_f32 v30, v30
    v_exp_f32 v31, v31
    v_cvt_pk_bf16_f32 v58, v28, v29
    v_exp_f32 v32, v32
    v_cvt_pk_bf16_f32 v59, v30, v31
    v_exp_f32 v33, v33
    v_exp_f32 v34, v34
    v_exp_f32 v35, v35
    v_mfma_f32_32x32x16_bf16 v[8:23], v[76:79], v[56:59], v[8:23]
    v_cvt_pk_bf16_f32 v60, v32, v33
    v_exp_f32 v36, v36
    v_cvt_pk_bf16_f32 v61, v34, v35
    v_exp_f32 v37, v37
    v_exp_f32 v38, v38
    v_exp_f32 v39, v39
    v_cvt_pk_bf16_f32 v62, v36, v37
    v_cvt_pk_bf16_f32 v63, v38, v39
    s_waitcnt lgkmcnt(0)
    v_mfma_f32_32x32x16_bf16 v[24:39], v[64:67], v[4:7], 0
    ds_read_b128 v[68:71], v88 offset:9216
    v_exp_f32 v40, v40
    v_exp_f32 v41, v41
    v_exp_f32 v42, v42
    v_exp_f32 v43, v43
    v_cvt_pk_bf16_f32 v56, v40, v41
    v_mfma_f32_32x32x16_bf16 v[8:23], v[84:87], v[60:63], v[8:23]
    v_exp_f32 v44, v44
    v_cvt_pk_bf16_f32 v57, v42, v43
    v_exp_f32 v45, v45
    v_exp_f32 v46, v46
    v_exp_f32 v47, v47
    v_cvt_pk_bf16_f32 v58, v44, v45
    v_exp_f32 v48, v48
    v_cvt_pk_bf16_f32 v59, v46, v47
    v_exp_f32 v49, v49
    v_exp_f32 v50, v50
    v_exp_f32 v51, v51
    v_mfma_f32_32x32x16_bf16 v[96:111], v[76:79], v[56:59], v[96:111]
    v_cvt_pk_bf16_f32 v60, v48, v49
    v_exp_f32 v52, v52
    v_cvt_pk_bf16_f32 v61, v50, v51
    v_exp_f32 v53, v53
    v_exp_f32 v54, v54
    v_exp_f32 v55, v55
    v_cvt_pk_bf16_f32 v62, v52, v53
    v_cvt_pk_bf16_f32 v63, v54, v55
    s_nop 1
    v_mfma_f32_32x32x16_bf16 v[96:111], v[84:87], v[60:63], v[96:111]
    s_branch attn_epi_22
slow_21:
    s_add_u32 m0, s54, 8192
    s_add_u32 s62, s54, 3153920
    buffer_load_dwordx4 v1, s[8:11], s62 offen sc1 lds
    buffer_load_dwordx4 v1, s[8:11], s62 offen offset:1024 sc1 lds
    s_add_u32 m0, s54, 73728
    s_add_u32 s62, s54, 3219456
    buffer_load_dwordx4 v1, s[8:11], s62 offen sc1 lds
    buffer_load_dwordx4 v1, s[8:11], s62 offen offset:1024 sc1 lds
    s_add_u32 m0, s54, 16384
    s_add_u32 s62, s54, 3162112
    buffer_load_dwordx4 v1, s[8:11], s62 offen sc1 lds
    buffer_load_dwordx4 v1, s[8:11], s62 offen offset:1024 sc1 lds
    s_add_u32 m0, s54, 81920
    s_add_u32 s62, s54, 3227648
    buffer_load_dwordx4 v1, s[8:11], s62 offen sc1 lds
    buffer_load_dwordx4 v1, s[8:11], s62 offen offset:1024 sc1 lds
    s_add_u32 m0, s54, 24576
    s_add_u32 s62, s54, 3170304
    buffer_load_dwordx4 v1, s[8:11], s62 offen sc1 lds
    buffer_load_dwordx4 v1, s[8:11], s62 offen offset:1024 sc1 lds
    s_add_u32 m0, s54, 90112
    s_add_u32 s62, s54, 3235840
    buffer_load_dwordx4 v1, s[8:11], s62 offen sc1 lds
    buffer_load_dwordx4 v1, s[8:11], s62 offen offset:1024 sc1 lds
    v_mov_b32 v8, 0
    v_mov_b32 v96, 0
    v_mov_b32 v9, 0
    v_mov_b32 v97, 0
    v_mov_b32 v10, 0
    v_mov_b32 v98, 0
    v_mov_b32 v11, 0
    v_mov_b32 v99, 0
    v_mov_b32 v12, 0
    v_mov_b32 v100, 0
    v_mov_b32 v13, 0
    v_mov_b32 v101, 0
    v_mov_b32 v14, 0
    v_mov_b32 v102, 0
    v_mov_b32 v15, 0
    v_mov_b32 v103, 0
    v_mov_b32 v16, 0
    v_mov_b32 v104, 0
    v_mov_b32 v17, 0
    v_mov_b32 v105, 0
    v_mov_b32 v18, 0
    v_mov_b32 v106, 0
    v_mov_b32 v19, 0
    v_mov_b32 v107, 0
    v_mov_b32 v20, 0
    v_mov_b32 v108, 0
    v_mov_b32 v21, 0
    v_mov_b32 v109, 0
    v_mov_b32 v22, 0
    v_mov_b32 v110, 0
    v_mov_b32 v23, 0
    v_mov_b32 v111, 0
    v_lshrrev_b32 v143, 4, v0
    v_and_b32 v144, 15, v0
    v_lshrrev_b32 v145, 5, v0
    v_lshrrev_b32 v146, 2, v144
    v_and_b32 v147, 3, v144
    v_and_b32 v148, 1, v147
    v_lshlrev_b32 v148, 1, v148
    v_lshrrev_b32 v149, 1, v147
    v_add_u32 v148, v148, v149
    v_lshlrev_b32 v148, 3, v148
    v_and_b32 v149, 1, v143
    v_lshl_add_u32 v150, v145, 3, v146
    s_lshl_b32 s57, s4, 12
    s_add_u32 s57, s57, 131072
    s_mov_b32 s78, 0
    s_cmp_ge_u32 s2, 112
    s_cbranch_scc1 wjo_49
    s_mov_b32 s78, 1
    s_lshr_b32 s60, s2, 2
    s_and_b32 s61, s2, 3
    s_lshl_b32 s62, s61, 3
    s_add_u32 s62, s62, s4
    s_mov_b32 s20, s28
    s_mov_b32 s21, s29
    s_mov_b32 s22, 0x1c0000
    s_mov_b32 s23, 0x00020000
    s_mov_b32 s36, s30
    s_mov_b32 s37, s31
    s_mov_b32 s38, 0x1c0000
    s_mov_b32 s39, 0x00020000
    v_lshrrev_b32 v151, 3, v0
    s_mov_b32 s63, 3584
    v_mul_lo_u32 v151, v151, s63
    v_and_b32 v152, 7, v0
    v_lshl_add_u32 v140, v152, 4, v151
    s_mul_i32 s58, s62, 57344
    s_lshl_b32 s63, s60, 7
    s_add_u32 s58, s58, s63
    v_lshlrev_b32 v151, 7, v150
    v_lshl_add_u32 v151, v149, 11, v151
    v_add_u32 v151, v151, v148
    v_add_u32 v141, s57, v151
    s_lshl_b32 s59, s60, 7
    s_add_u32 s59, s59, s62
    s_lshl_b32 s59, s59, 10
    s_add_u32 s59, s59, 9437184
    s_mul_i32 s72, s61, 112
    s_lshl_b32 s63, s60, 2
    s_add_u32 s72, s72, s63
    s_lshl_b32 s72, s72, 7
    s_add_u32 s72, s72, 3407872
    v_lshlrev_b32 v151, 2, v0
    v_add_u32 v142, s57, v151
    s_branch wjd_50
wjo_49:
    s_cmp_ge_u32 s2, 184
    s_cbranch_scc1 wjd_50
    s_sub_u32 s60, s2, 112
    s_lshl_b32 s60, s60, 3
    s_add_u32 s60, s60, s4
    s_cmp_ge_u32 s60, 128
    s_cbranch_scc1 wjwd_51
    s_mov_b32 s78, 3
    s_mov_b32 s20, s24
    s_mov_b32 s21, s25
    s_mov_b32 s22, 0x80000
    s_mov_b32 s23, 0x00020000
    s_lshr_b32 s61, s60, 3
    s_and_b32 s62, s60, 7
    v_lshrrev_b32 v151, 3, v0
    v_lshlrev_b32 v151, 10, v151
    v_and_b32 v152, 7, v0
    v_lshl_add_u32 v140, v152, 4, v151
    s_lshl_b32 s58, s61, 15
    s_lshl_b32 s60, s62, 7
    s_add_u32 s58, s58, s60
    s_mov_b32 s69, 8192
    v_lshl_add_u32 v151, v143, 3, v146
    v_lshlrev_b32 v151, 7, v151
    v_lshl_add_u32 v151, v147, 3, v151
    v_add_u32 v141, s57, v151
    s_lshl_b32 s59, s62, 6
    s_add_u32 s59, s59, s61
    s_lshl_b32 s59, s59, 10
    s_add_u32 s59, s59, 3670016
    s_mov_b32 s72, 16384
    s_branch wjd_50
wjwd_51:
    s_mov_b32 s78, 2
    s_sub_u32 s60, s60, 128
    s_mov_b32 s20, s32
    s_mov_b32 s21, s33
    s_mov_b32 s22, 0x1c0000
    s_mov_b32 s23, 0x00020000
    s_lshr_b32 s61, s60, 2
    s_and_b32 s62, s60, 3
    v_lshlrev_b32 v151, 10, v143
    v_lshl_add_u32 v140, v144, 4, v151
    s_lshl_b32 s58, s61, 14
    s_lshl_b32 s60, s62, 8
    s_add_u32 s58, s58, s60
    s_mov_b32 s69, 4096
    v_lshlrev_b32 v151, 8, v150
    v_lshl_add_u32 v151, v149, 5, v151
    v_add_u32 v151, v151, v148
    v_add_u32 v141, s57, v151
    s_lshl_b32 s59, s62, 2
    s_mul_i32 s59, s59, 112
    s_add_u32 s59, s59, s61
    s_lshl_b32 s59, s59, 10
    s_add_u32 s59, s59, 7405568
    s_mov_b32 s72, 114688
wjd_50:
    s_cmp_eq_u32 s78, 1
    s_cbranch_scc0 jo_52
    s_add_u32 m0, s57, 0
    s_add_u32 s63, s58, 0
    buffer_load_dwordx4 v140, s[20:23], s63 offen lds
    s_add_u32 m0, s57, 2048
    s_nop 0
    buffer_load_dwordx4 v140, s[36:39], s63 offen lds
    s_add_u32 m0, s57, 1024
    s_add_u32 s63, s58, 28672
    buffer_load_dwordx4 v140, s[20:23], s63 offen lds
    s_add_u32 m0, s57, 3072
    s_nop 0
    buffer_load_dwordx4 v140, s[36:39], s63 offen lds
    s_branch je_53
jo_52:
    s_cmp_eq_u32 s78, 0
    s_cbranch_scc1 je_53
    s_add_u32 m0, s57, 0
    s_mul_i32 s63, s69, 0
    s_add_u32 s63, s63, s58
    buffer_load_dwordx4 v140, s[20:23], s63 offen lds
    s_add_u32 m0, s57, 1024
    s_mul_i32 s63, s69, 1
    s_add_u32 s63, s63, s58
    buffer_load_dwordx4 v140, s[20:23], s63 offen lds
    s_add_u32 m0, s57, 2048
    s_mul_i32 s63, s69, 2
    s_add_u32 s63, s63, s58
    buffer_load_dwordx4 v140, s[20:23], s63 offen lds
    s_add_u32 m0, s57, 3072
    s_mul_i32 s63, s69, 3
    s_add_u32 s63, s63, s58
    buffer_load_dwordx4 v140, s[20:23], s63 offen lds
je_53:
    s_cmp_eq_u32 s78, 0
    s_cbranch_scc1 jre_55
    s_cmp_eq_u32 s78, 2
    s_cbranch_scc1 jr2_54
    s_waitcnt vmcnt(0)
    ds_read_b64_tr_b16 v[112:113], v141 offset:0
    ds_read_b64_tr_b16 v[114:115], v141 offset:512
    ds_read_b64_tr_b16 v[116:117], v141 offset:32
    ds_read_b64_tr_b16 v[118:119], v141 offset:544
    ds_read_b64_tr_b16 v[120:121], v141 offset:64
    ds_read_b64_tr_b16 v[122:123], v141 offset:576
    ds_read_b64_tr_b16 v[124:125], v141 offset:96
    ds_read_b64_tr_b16 v[126:127], v141 offset:608
    s_branch jre_55
jr2_54:
    s_waitcnt vmcnt(0)
    ds_read_b64_tr_b16 v[112:113], v141 offset:0
    ds_read_b64_tr_b16 v[114:115], v141 offset:1024
    ds_read_b64_tr_b16 v[116:117], v141 offset:64
    ds_read_b64_tr_b16 v[118:119], v141 offset:1088
    ds_read_b64_tr_b16 v[120:121], v141 offset:128
    ds_read_b64_tr_b16 v[122:123], v141 offset:1152
    ds_read_b64_tr_b16 v[124:125], v141 offset:192
    ds_read_b64_tr_b16 v[126:127], v141 offset:1216
jre_55:
    s_waitcnt lgkmcnt(0)
    s_cmp_eq_u32 s78, 1
    s_cbranch_scc0 jo_56
    v_mov_b32 v128, 0x3f803f80
    v_mov_b32 v129, 0x3f803f80
    v_mov_b32 v130, 0x3f803f80
    v_mov_b32 v131, 0x3f803f80
    s_add_u32 s63, s59, 0
    buffer_store_dwordx4 v[112:115], v1, s[8:11], s63 offen sc1
    s_add_u32 s63, s59, 32768
    buffer_store_dwordx4 v[116:119], v1, s[8:11], s63 offen sc1
    s_add_u32 s63, s59, 65536
    buffer_store_dwordx4 v[120:123], v1, s[8:11], s63 offen sc1
    s_add_u32 s63, s59, 98304
    buffer_store_dwordx4 v[124:127], v1, s[8:11], s63 offen sc1
    v_mfma_f32_32x32x16_bf16 v[160:175], v[128:131], v[112:115], 0
    v_mfma_f32_32x32x16_bf16 v[176:191], v[128:131], v[116:119], 0
    v_mfma_f32_32x32x16_bf16 v[192:207], v[128:131], v[120:123], 0
    v_mfma_f32_32x32x16_bf16 v[208:223], v[128:131], v[124:127], 0
    s_branch je_57
jo_56:
    s_cmp_eq_u32 s78, 0
    s_cbranch_scc1 je_57
    s_mov_b32 s63, s59
    buffer_store_dwordx4 v[112:115], v1, s[8:11], s63 offen sc1
    s_add_u32 s63, s63, s72
    buffer_store_dwordx4 v[116:119], v1, s[8:11], s63 offen sc1
    s_add_u32 s63, s63, s72
    buffer_store_dwordx4 v[120:123], v1, s[8:11], s63 offen sc1
    s_add_u32 s63, s63, s72
    buffer_store_dwordx4 v[124:127], v1, s[8:11], s63 offen sc1
je_57:
    s_nop 15
    s_cmp_eq_u32 s78, 1
    s_cbranch_scc0 jo_58
    s_mov_b32 exec_hi, 0
    ds_write_b32 v142, v160 offset:0
    ds_write_b32 v142, v176 offset:128
    ds_write_b32 v142, v192 offset:256
    ds_write_b32 v142, v208 offset:384
    s_mov_b64 exec, -1
    s_branch je_59
jo_58:
je_59:
    s_waitcnt vmcnt(0) lgkmcnt(0)
    s_barrier
    s_cmp_eq_u32 s78, 1
    s_cbranch_scc0 jo_60
    s_cmp_ge_u32 s4, 2
    s_cbranch_scc1 csr_62
    s_lshl_b32 s63, s4, 8
    v_lshlrev_b32 v132, 2, v0
    v_add_u32 v132, s63, v132
    v_add_u32 v133, 131072, v132
    ds_read_b32 v112, v133 offset:0
    ds_read_b32 v113, v133 offset:4096
    ds_read_b32 v114, v133 offset:8192
    ds_read_b32 v115, v133 offset:12288
    ds_read_b32 v116, v133 offset:16384
    ds_read_b32 v117, v133 offset:20480
    ds_read_b32 v118, v133 offset:24576
    ds_read_b32 v119, v133 offset:28672
csr_62:
    s_branch je_61
jo_60:
je_61:
    s_waitcnt lgkmcnt(0)
    s_cmp_eq_u32 s78, 1
    s_cbranch_scc0 jo_63
    s_cmp_ge_u32 s4, 2
    s_cbranch_scc1 css_65
    v_add_f32 v112, v112, v113
    v_add_f32 v112, v112, v114
    v_add_f32 v112, v112, v115
    v_add_f32 v112, v112, v116
    v_add_f32 v112, v112, v117
    v_add_f32 v112, v112, v118
    v_add_f32 v112, v112, v119
    buffer_store_dword v112, v132, s[8:11], s72 offen sc1
css_65:
    s_branch je_64
jo_63:
je_64:
    s_waitcnt vmcnt(0)
    s_barrier
    s_cmp_eq_u32 s78, 0
    s_cbranch_scc1 wsig_66
    s_cmp_lg_u32 s4, 0
    s_cbranch_scc1 wsig_66
    s_lshl_b32 s63, s2, 7
    s_add_u32 s63, s63, 23142400
    v_mov_b32 v112, s56
    v_lshlrev_b32 v113, 2, v0
    s_mov_b32 exec_hi, 0
    buffer_store_dword v112, v113, s[8:11], s63 offen sc1
    s_mov_b64 exec, -1
wsig_66:
    v_mov_b32 v2, 0xff800000
    v_mov_b32 v90, v88
    s_mov_b32 s55, 0
s1_67:
    ds_read_b128 v[64:67], v90
    s_waitcnt lgkmcnt(0)
    v_mfma_f32_32x32x16_bf16 v[24:39], v[64:67], v[4:7], 0
    s_nop 15
    v_max3_f32 v2, v24, v25, v2
    v_max3_f32 v2, v26, v27, v2
    v_max3_f32 v2, v28, v29, v2
    v_max3_f32 v2, v30, v31, v2
    v_max3_f32 v2, v32, v33, v2
    v_max3_f32 v2, v34, v35, v2
    v_max3_f32 v2, v36, v37, v2
    v_max3_f32 v2, v38, v39, v2
    v_add_u32 v90, 1024, v90
    s_add_u32 s55, s55, 1
    s_cmp_lt_u32 s55, 32
    s_cbranch_scc1 s1_67
    v_mov_b32 v91, v2
    s_nop 1
    v_permlane32_swap_b32 v2, v91
    s_nop 1
    v_max_f32 v2, v2, v91
    v_mov_b32 v3, 0xff800000
    v_mov_b32 v90, v88
    s_mov_b32 s55, 0
s1_68:
    ds_read_b128 v[64:67], v90
    s_waitcnt lgkmcnt(0)
    v_mfma_f32_32x32x16_bf16 v[24:39], v[64:67], v[92:95], 0
    s_nop 15
    v_max3_f32 v3, v24, v25, v3
    v_max3_f32 v3, v26, v27, v3
    v_max3_f32 v3, v28, v29, v3
    v_max3_f32 v3, v30, v31, v3
    v_max3_f32 v3, v32, v33, v3
    v_max3_f32 v3, v34, v35, v3
    v_max3_f32 v3, v36, v37, v3
    v_max3_f32 v3, v38, v39, v3
    v_add_u32 v90, 1024, v90
    s_add_u32 s55, s55, 1
    s_cmp_lt_u32 s55, 32
    s_cbranch_scc1 s1_68
    v_mov_b32 v91, v3
    s_nop 1
    v_permlane32_swap_b32 v3, v91
    s_nop 1
    v_max_f32 v3, v3, v91
    s_lshl_b32 s55, s4, 12
    s_add_u32 s55, s55, 131072
    v_lshlrev_b32 v90, 3, v0
    v_add_u32 v91, s55, v90
    ds_write_b64 v91, v[2:3]
    s_xor_b32 s55, s4, 4
    s_lshl_b32 s55, s55, 12
    s_add_u32 s55, s55, 131072
    v_add_u32 v91, s55, v90
    s_waitcnt lgkmcnt(0)
    s_barrier
    ds_read_b64 v[90:91], v91
    s_waitcnt lgkmcnt(0)
    v_max_f32 v2, v2, v90
    v_max_f32 v3, v3, v91
    v_sub_f32 v112, 0, v2
    v_sub_f32 v113, 0, v2
    v_sub_f32 v114, 0, v2
    v_sub_f32 v115, 0, v2
    v_sub_f32 v116, 0, v2
    v_sub_f32 v117, 0, v2
    v_sub_f32 v118, 0, v2
    v_sub_f32 v119, 0, v2
    v_sub_f32 v120, 0, v2
    v_sub_f32 v121, 0, v2
    v_sub_f32 v122, 0, v2
    v_sub_f32 v123, 0, v2
    v_sub_f32 v124, 0, v2
    v_sub_f32 v125, 0, v2
    v_sub_f32 v126, 0, v2
    v_sub_f32 v127, 0, v2
    v_sub_f32 v128, 0, v3
    v_sub_f32 v129, 0, v3
    v_sub_f32 v130, 0, v3
    v_sub_f32 v131, 0, v3
    v_sub_f32 v132, 0, v3
    v_sub_f32 v133, 0, v3
    v_sub_f32 v134, 0, v3
    v_sub_f32 v135, 0, v3
    v_sub_f32 v136, 0, v3
    v_sub_f32 v137, 0, v3
    v_sub_f32 v138, 0, v3
    v_sub_f32 v139, 0, v3
    v_sub_f32 v140, 0, v3
    v_sub_f32 v141, 0, v3
    v_sub_f32 v142, 0, v3
    v_sub_f32 v143, 0, v3
    v_mov_b32 v90, v88
    v_mov_b32 v91, v89
    s_mov_b32 s55, 0
s2_69:
    ds_read_b128 v[64:67], v90
    s_mov_b64 exec, s[70:71]
    ds_read_b128 v[72:75], v91
    ds_read_b128 v[80:83], v91 offset:512
    s_mov_b64 exec, -1
    s_waitcnt lgkmcnt(0)
    v_mfma_f32_32x32x16_bf16 v[24:39], v[64:67], v[4:7], v[112:127]
    s_nop 15
    v_exp_f32 v24, v24
    v_exp_f32 v25, v25
    v_exp_f32 v26, v26
    v_exp_f32 v27, v27
    v_exp_f32 v28, v28
    v_exp_f32 v29, v29
    v_exp_f32 v30, v30
    v_exp_f32 v31, v31
    v_exp_f32 v32, v32
    v_exp_f32 v33, v33
    v_exp_f32 v34, v34
    v_exp_f32 v35, v35
    v_exp_f32 v36, v36
    v_exp_f32 v37, v37
    v_exp_f32 v38, v38
    v_exp_f32 v39, v39
    s_nop 0
    v_cvt_pk_bf16_f32 v56, v24, v25
    v_cvt_pk_bf16_f32 v57, v26, v27
    v_cvt_pk_bf16_f32 v58, v28, v29
    v_cvt_pk_bf16_f32 v59, v30, v31
    v_cvt_pk_bf16_f32 v60, v32, v33
    v_cvt_pk_bf16_f32 v61, v34, v35
    v_cvt_pk_bf16_f32 v62, v36, v37
    v_cvt_pk_bf16_f32 v63, v38, v39
    s_nop 1
    v_mfma_f32_32x32x16_bf16 v[8:23], v[72:75], v[56:59], v[8:23]
    v_mfma_f32_32x32x16_bf16 v[8:23], v[80:83], v[60:63], v[8:23]
    v_add_u32 v90, 1024, v90
    v_add_u32 v91, 1024, v91
    s_add_u32 s55, s55, 1
    s_cmp_lt_u32 s55, 32
    s_cbranch_scc1 s2_69
    v_mov_b32 v90, v88
    v_mov_b32 v91, v89
    s_mov_b32 s55, 0
s2_70:
    ds_read_b128 v[64:67], v90
    s_mov_b64 exec, s[70:71]
    ds_read_b128 v[72:75], v91
    ds_read_b128 v[80:83], v91 offset:512
    s_mov_b64 exec, -1
    s_waitcnt lgkmcnt(0)
    v_mfma_f32_32x32x16_bf16 v[24:39], v[64:67], v[92:95], v[128:143]
    s_nop 15
    v_exp_f32 v24, v24
    v_exp_f32 v25, v25
    v_exp_f32 v26, v26
    v_exp_f32 v27, v27
    v_exp_f32 v28, v28
    v_exp_f32 v29, v29
    v_exp_f32 v30, v30
    v_exp_f32 v31, v31
    v_exp_f32 v32, v32
    v_exp_f32 v33, v33
    v_exp_f32 v34, v34
    v_exp_f32 v35, v35
    v_exp_f32 v36, v36
    v_exp_f32 v37, v37
    v_exp_f32 v38, v38
    v_exp_f32 v39, v39
    s_nop 0
    v_cvt_pk_bf16_f32 v56, v24, v25
    v_cvt_pk_bf16_f32 v57, v26, v27
    v_cvt_pk_bf16_f32 v58, v28, v29
    v_cvt_pk_bf16_f32 v59, v30, v31
    v_cvt_pk_bf16_f32 v60, v32, v33
    v_cvt_pk_bf16_f32 v61, v34, v35
    v_cvt_pk_bf16_f32 v62, v36, v37
    v_cvt_pk_bf16_f32 v63, v38, v39
    s_nop 1
    v_mfma_f32_32x32x16_bf16 v[96:111], v[72:75], v[56:59], v[96:111]
    v_mfma_f32_32x32x16_bf16 v[96:111], v[80:83], v[60:63], v[96:111]
    v_add_u32 v90, 1024, v90
    v_add_u32 v91, 1024, v91
    s_add_u32 s55, s55, 1
    s_cmp_lt_u32 s55, 32
    s_cbranch_scc1 s2_70
    s_nop 15
    s_barrier
    s_cmp_lg_u32 s4, 0
    s_cbranch_scc1 wrq_71
    v_lshlrev_b32 v2, 7, v0
    v_add_u32 v3, 128, v0
    v_min_u32 v3, 183, v3
    v_lshlrev_b32 v3, 7, v3
    s_mov_b32 s63, 23142400
    buffer_load_dword v112, v2, s[8:11], s63 offen sc1
    s_mov_b32 s63, 23150592
    buffer_load_dword v113, v2, s[8:11], s63 offen sc1
    s_mov_b32 s63, 23142400
    buffer_load_dword v114, v3, s[8:11], s63 offen sc1
wrq_71:
    v_lshlrev_b32 v118, 7, v0
    s_lshl_b32 s62, s5, 11
    s_add_u32 s62, s62, 23207936
    s_mov_b64 exec, 0xffff
    buffer_load_dwordx2 v[116:117], v118, s[8:11], s62 offen sc1
    s_mov_b64 exec, -1
    s_cmp_lg_u32 s4, 0
    s_cbranch_scc1 wrc_72
    s_waitcnt vmcnt(0)
    v_cmp_ne_u32 vcc, s56, v112
    v_cmp_ne_u32 s[62:63], s56, v113
    s_nop 1
    s_or_b64 s[62:63], s[62:63], vcc
    v_cmp_ne_u32 vcc, s56, v114
    s_nop 4
    s_or_b64 vcc, vcc, s[62:63]
    s_cbranch_vccz wrd_73
    s_mov_b32 s79, 400000
wrp_74:
    s_mov_b32 s63, 23142400
    buffer_load_dword v112, v2, s[8:11], s63 offen sc1
    buffer_load_dword v114, v3, s[8:11], s63 offen sc1
    s_mov_b32 s63, 23150592
    buffer_load_dword v113, v2, s[8:11], s63 offen sc1
    s_waitcnt vmcnt(0)
    v_cmp_ne_u32 vcc, s56, v112
    v_cmp_ne_u32 s[62:63], s56, v113
    s_nop 1
    s_or_b64 s[62:63], s[62:63], vcc
    v_cmp_ne_u32 vcc, s56, v114
    s_nop 4
    s_or_b64 vcc, vcc, s[62:63]
    s_nop 4
    s_cbranch_vccz wrd_73
    s_sleep 4
    s_sub_u32 s79, s79, 1
    s_cmp_lg_u32 s79, 0
    s_cbranch_scc1 wrp_74
wrd_73:
wrc_72:
    s_barrier
    s_lshl_b32 s62, s5, 11
    s_add_u32 s62, s62, 23207936
    s_mov_b64 exec, 0xffff
    s_waitcnt vmcnt(0)
    v_cmp_ne_u32 vcc, s56, v116
    s_nop 4
    s_cbranch_vccz lcd_75
    s_mov_b32 s79, 400000
lcp_76:
    buffer_load_dwordx2 v[116:117], v118, s[8:11], s62 offen sc1
    s_waitcnt vmcnt(0)
    v_cmp_ne_u32 vcc, s56, v116
    s_nop 4
    s_cbranch_vccz lcd_75
    s_sleep 4
    s_sub_u32 s79, s79, 1
    s_cmp_lg_u32 s79, 0
    s_cbranch_scc1 lcp_76
lcd_75:
    s_getreg_b32 s62, hwreg(HW_REG_XCC_ID, 0, 4)
    v_cmp_ne_u32 vcc, s62, v117
    v_cmp_ne_u32 s[62:63], s56, v116
    s_mov_b64 exec, -1
    s_nop 2
    s_or_b64 vcc, vcc, s[62:63]
    s_cmp_eq_u64 vcc, 0
    s_cselect_b32 s69, 1, 0
    s_add_u32 s75, s73, 12288
    buffer_load_dwordx4 v[176:179], v1, s[8:11], s75 offen offset:0 sc1
    s_add_u32 s75, s73, 12288
    buffer_load_dwordx4 v[180:183], v1, s[8:11], s75 offen offset:1024 sc1
    s_add_u32 s75, s73, 12288
    buffer_load_dwordx4 v[184:187], v1, s[8:11], s75 offen offset:2048 sc1
    s_add_u32 s75, s73, 12288
    buffer_load_dwordx4 v[188:191], v1, s[8:11], s75 offen offset:3072 sc1
    s_add_u32 s75, s73, 16384
    buffer_load_dwordx4 v[192:195], v1, s[8:11], s75 offen offset:0 sc1
    s_add_u32 s75, s73, 16384
    buffer_load_dwordx4 v[196:199], v1, s[8:11], s75 offen offset:1024 sc1
    s_add_u32 s75, s73, 16384
    buffer_load_dwordx4 v[200:203], v1, s[8:11], s75 offen offset:2048 sc1
    s_add_u32 s75, s73, 16384
    buffer_load_dwordx4 v[204:207], v1, s[8:11], s75 offen offset:3072 sc1
    s_add_u32 s75, s73, 20480
    buffer_load_dwordx4 v[208:211], v1, s[8:11], s75 offen offset:0 sc1
    s_add_u32 s75, s73, 20480
    buffer_load_dwordx4 v[212:215], v1, s[8:11], s75 offen offset:1024 sc1
    s_add_u32 s75, s73, 20480
    buffer_load_dwordx4 v[216:219], v1, s[8:11], s75 offen offset:2048 sc1
    s_add_u32 s75, s73, 20480
    buffer_load_dwordx4 v[220:223], v1, s[8:11], s75 offen offset:3072 sc1
    s_add_u32 s75, s73, 24576
    buffer_load_dwordx4 v[224:227], v1, s[8:11], s75 offen offset:0 sc1
    s_add_u32 s75, s73, 24576
    buffer_load_dwordx4 v[228:231], v1, s[8:11], s75 offen offset:1024 sc1
    s_add_u32 s75, s73, 24576
    buffer_load_dwordx4 v[232:235], v1, s[8:11], s75 offen offset:2048 sc1
    s_add_u32 s75, s73, 24576
    buffer_load_dwordx4 v[236:239], v1, s[8:11], s75 offen offset:3072 sc1
    s_add_u32 s75, s73, 28672
    buffer_load_dwordx4 v[240:243], v1, s[8:11], s75 offen offset:0 sc1
    s_add_u32 s75, s73, 28672
    buffer_load_dwordx4 v[244:247], v1, s[8:11], s75 offen offset:1024 sc1
    s_add_u32 s75, s73, 28672
    buffer_load_dwordx4 v[248:251], v1, s[8:11], s75 offen offset:2048 sc1
    s_add_u32 s75, s73, 28672
    buffer_load_dwordx4 v[252:255], v1, s[8:11], s75 offen offset:3072 sc1
    s_add_u32 s75, s68, 0
    buffer_load_dwordx4 v[112:115], v1, s[8:11], s75 offen offset:0 sc1
    s_add_u32 s75, s68, 0
    buffer_load_dwordx4 v[116:119], v1, s[8:11], s75 offen offset:1024 sc1
    s_add_u32 s75, s68, 0
    buffer_load_dwordx4 v[120:123], v1, s[8:11], s75 offen offset:2048 sc1
    s_add_u32 s75, s68, 0
    buffer_load_dwordx4 v[124:127], v1, s[8:11], s75 offen offset:3072 sc1
    s_add_u32 s75, s68, 4096
    buffer_load_dwordx4 v[128:131], v1, s[8:11], s75 offen offset:0 sc1
    s_add_u32 s75, s68, 4096
    buffer_load_dwordx4 v[132:135], v1, s[8:11], s75 offen offset:1024 sc1
    s_add_u32 s75, s68, 4096
    buffer_load_dwordx4 v[136:139], v1, s[8:11], s75 offen offset:2048 sc1
    s_add_u32 s75, s68, 4096
    buffer_load_dwordx4 v[140:143], v1, s[8:11], s75 offen offset:3072 sc1
    s_add_u32 s75, s68, 8192
    buffer_load_dwordx4 v[144:147], v1, s[8:11], s75 offen offset:0 sc1
    s_add_u32 s75, s68, 8192
    buffer_load_dwordx4 v[148:151], v1, s[8:11], s75 offen offset:1024 sc1
    s_add_u32 s75, s68, 8192
    buffer_load_dwordx4 v[152:155], v1, s[8:11], s75 offen offset:2048 sc1
    s_add_u32 s75, s68, 8192
    buffer_load_dwordx4 v[156:159], v1, s[8:11], s75 offen offset:3072 sc1
    s_add_u32 s75, s68, 12288
    buffer_load_dwordx4 v[160:163], v1, s[8:11], s75 offen offset:0 sc1
    s_add_u32 s75, s68, 12288
    buffer_load_dwordx4 v[164:167], v1, s[8:11], s75 offen offset:1024 sc1
    s_add_u32 s75, s68, 12288
    buffer_load_dwordx4 v[168:171], v1, s[8:11], s75 offen offset:2048 sc1
    s_add_u32 s75, s68, 12288
    buffer_load_dwordx4 v[172:175], v1, s[8:11], s75 offen offset:3072 sc1
    s_mov_b32 s12, s16
    s_mov_b32 s13, s17
    s_mov_b32 s14, 0x200000
    s_mov_b32 s15, 0x00020000
    v_and_b32 v2, 15, v0
    v_lshrrev_b32 v3, 4, v0
    v_lshlrev_b32 v2, 10, v2
    v_lshl_add_u32 v2, v3, 3, v2
    s_lshl_b32 s62, s7, 15
    s_lshl_b32 s63, s52, 8
    s_add_u32 s62, s62, s63
    s_lshl_b32 s63, s4, 5
    s_add_u32 s62, s62, s63
    buffer_load_dwordx2 v[4:5], v2, s[12:15], s62 offen
    s_add_u32 s62, s62, 16384
    buffer_load_dwordx2 v[6:7], v2, s[12:15], s62 offen
attn_epi_22:
    s_lshl_b32 s60, s4, 12
    s_add_u32 s60, s60, 131072
    v_add_u32 v90, s60, v1
    s_xor_b32 s60, s4, 4
    s_lshl_b32 s60, s60, 12
    s_add_u32 s60, s60, 131072
    v_add_u32 v91, s60, v1
    s_lshl_b32 s60, s7, 5
    s_lshl_b32 s61, s52, 3
    s_add_u32 s60, s60, s61
    s_and_b32 s61, s4, 3
    s_lshl_b32 s61, s61, 1
    s_add_u32 s60, s60, s61
    s_lshr_b32 s61, s4, 2
    s_add_u32 s60, s60, s61
    s_lshl_b32 s60, s60, 10
    s_add_u32 s60, s60, 1048576
    s_cmp_ge_u32 s4, 4
    s_cbranch_scc1 kh1_77
    ds_write_b128 v90, v[96:99] offset:0
    ds_write_b128 v90, v[100:103] offset:1024
    ds_write_b128 v90, v[104:107] offset:2048
    s_branch khj_78
kh1_77:
    ds_write_b128 v90, v[8:11] offset:0
    ds_write_b128 v90, v[12:15] offset:1024
    ds_write_b128 v90, v[16:19] offset:2048
    v_mov_b32 v8, v96
    v_mov_b32 v9, v97
    v_mov_b32 v10, v98
    v_mov_b32 v11, v99
    v_mov_b32 v12, v100
    v_mov_b32 v13, v101
    v_mov_b32 v14, v102
    v_mov_b32 v15, v103
    v_mov_b32 v16, v104
khj_78:
    s_waitcnt lgkmcnt(0)
    s_barrier
    ds_read_b128 v[24:27], v91 offset:0
    ds_read_b128 v[28:31], v91 offset:1024
    ds_read_b128 v[32:35], v91 offset:2048
    s_waitcnt lgkmcnt(0)
    v_pk_add_f32 v[8:9], v[8:9], v[24:25]
    v_pk_add_f32 v[10:11], v[10:11], v[26:27]
    v_pk_add_f32 v[12:13], v[12:13], v[28:29]
    v_pk_add_f32 v[14:15], v[14:15], v[30:31]
    v_add_f32 v16, v16, v32
    v_rcp_f32 v90, v16
    s_nop 0
    v_mul_f32 v8, v8, v90
    v_mul_f32 v9, v9, v90
    v_mul_f32 v10, v10, v90
    v_mul_f32 v11, v11, v90
    v_mul_f32 v12, v12, v90
    v_mul_f32 v13, v13, v90
    v_mul_f32 v14, v14, v90
    v_mul_f32 v15, v15, v90
    v_cvt_pk_bf16_f32 v56, v8, v9
    v_cvt_pk_bf16_f32 v57, v10, v11
    v_cvt_pk_bf16_f32 v58, v12, v13
    v_cvt_pk_bf16_f32 v59, v14, v15
    s_mov_b32 s54, s60
    buffer_store_dwordx4 v[56:59], v1, s[8:11], s60 offen sc1
    s_lshl_b32 s60, s5, 4
    s_add_u32 s60, s60, s6
    s_lshl_b32 s60, s60, 7
    s_add_u32 s60, s60, 23265280
    v_mov_b32 v28, s56
    v_lshlrev_b32 v29, 2, v0
    s_waitcnt vmcnt(0)
    s_barrier
    s_cmp_lg_u32 s4, 0
    s_cbranch_scc1 pub_79
    s_mov_b32 exec_hi, 0
    s_cmp_eq_u32 s69, 1
    s_cbranch_scc1 gl_80
    buffer_store_dword v28, v29, s[8:11], s60 offen sc1
    s_branch ge_81
gl_80:
    buffer_store_dword v28, v29, s[8:11], s60 offen
ge_81:
    s_mov_b64 exec, -1
pub_79:
    s_cmp_lg_u32 s4, 1
    s_cbranch_scc1 wt_82
    s_lshl_b32 s60, s5, 4
    s_lshl_b32 s61, s53, 2
    s_add_u32 s60, s60, s61
    s_lshl_b32 s60, s60, 7
    s_add_u32 s60, s60, 23265280
    v_lshlrev_b32 v30, 7, v0
    s_mov_b64 exec, 0xf
    s_mov_b32 s79, 400000
pl_84:
    buffer_load_dword v28, v30, s[8:11], s60 offen sc1
    s_waitcnt vmcnt(0)
    v_cmp_ne_u32 vcc, s56, v28
    s_nop 4
    s_cbranch_vccz pd_83
    s_sleep 1
    s_sub_u32 s79, s79, 1
    s_cmp_lg_u32 s79, 0
    s_cbranch_scc1 pl_84
pd_83:
    s_mov_b64 exec, -1
wt_82:
    s_barrier
    s_lshl_b32 s60, s4, 12
    s_mov_b32 m0, s60
    s_lshl_b32 s61, s7, 15
    s_add_u32 s61, s61, s60
    s_add_u32 s61, s61, 1048576
    buffer_load_dwordx4 v1, s[8:11], s61 offen offset:0 sc1 lds
    buffer_load_dwordx4 v1, s[8:11], s61 offen offset:1024 sc1 lds
    buffer_load_dwordx4 v1, s[8:11], s61 offen offset:2048 sc1 lds
    buffer_load_dwordx4 v1, s[8:11], s61 offen offset:3072 sc1 lds
    v_lshrrev_b32 v30, 5, v0
    v_lshlrev_b32 v30, 10, v30
    v_bfe_u32 v31, v0, 4, 1
    v_lshlrev_b32 v31, 5, v31
    v_and_b32 v29, 15, v0
    v_add_u32 v31, v31, v29
    v_lshl_add_u32 v30, v31, 4, v30
    v_and_b32 v2, 31, v0
    s_mov_b32 s61, 0xffff0000
    v_lshlrev_b32 v16, 16, v4
    v_and_b32 v17, s61, v4
    v_lshlrev_b32 v18, 16, v5
    v_and_b32 v19, s61, v5
    v_lshlrev_b32 v20, 16, v6
    v_and_b32 v21, s61, v6
    v_lshlrev_b32 v22, 16, v7
    v_and_b32 v23, s61, v7
    s_lshl_b32 s60, s7, 5
    s_lshl_b32 s61, s52, 3
    s_add_u32 s60, s60, s61
    s_add_u32 s60, s60, s4
    s_lshl_b32 s60, s60, 10
    s_add_u32 s60, s60, 5242880
    s_waitcnt vmcnt(0)
    s_barrier
    ds_read_b128 v[32:35], v30 offset:0
    ds_read_b128 v[36:39], v30 offset:256
    ds_read_b128 v[40:43], v30 offset:2048
    ds_read_b128 v[44:47], v30 offset:2304
    ds_read_b128 v[48:51], v30 offset:4096
    ds_read_b128 v[52:55], v30 offset:4352
    ds_read_b128 v[56:59], v30 offset:6144
    ds_read_b128 v[60:63], v30 offset:6400
    ds_read_b128 v[64:67], v30 offset:8192
    ds_read_b128 v[68:71], v30 offset:8448
    s_waitcnt lgkmcnt(8)
    v_mfma_f32_16x16x32_bf16 v[8:11], v[112:115], v[32:35], 0
    v_mfma_f32_16x16x32_bf16 v[12:15], v[112:115], v[36:39], 0
    ds_read_b128 v[32:35], v30 offset:10240
    ds_read_b128 v[36:39], v30 offset:10496
    s_waitcnt lgkmcnt(8)
    v_mfma_f32_16x16x32_bf16 v[8:11], v[116:119], v[40:43], v[8:11]
    v_mfma_f32_16x16x32_bf16 v[12:15], v[116:119], v[44:47], v[12:15]
    ds_read_b128 v[40:43], v30 offset:12288
    ds_read_b128 v[44:47], v30 offset:12544
    s_waitcnt lgkmcnt(8)
    v_mfma_f32_16x16x32_bf16 v[8:11], v[120:123], v[48:51], v[8:11]
    v_mfma_f32_16x16x32_bf16 v[12:15], v[120:123], v[52:55], v[12:15]
    ds_read_b128 v[48:51], v30 offset:14336
    ds_read_b128 v[52:55], v30 offset:14592
    s_waitcnt lgkmcnt(8)
    v_mfma_f32_16x16x32_bf16 v[8:11], v[124:127], v[56:59], v[8:11]
    v_mfma_f32_16x16x32_bf16 v[12:15], v[124:127], v[60:63], v[12:15]
    ds_read_b128 v[56:59], v30 offset:16384
    ds_read_b128 v[60:63], v30 offset:16640
    s_waitcnt lgkmcnt(8)
    v_mfma_f32_16x16x32_bf16 v[8:11], v[128:131], v[64:67], v[8:11]
    v_mfma_f32_16x16x32_bf16 v[12:15], v[128:131], v[68:71], v[12:15]
    ds_read_b128 v[64:67], v30 offset:18432
    ds_read_b128 v[68:71], v30 offset:18688
    s_waitcnt lgkmcnt(8)
    v_mfma_f32_16x16x32_bf16 v[8:11], v[132:135], v[32:35], v[8:11]
    v_mfma_f32_16x16x32_bf16 v[12:15], v[132:135], v[36:39], v[12:15]
    ds_read_b128 v[32:35], v30 offset:20480
    ds_read_b128 v[36:39], v30 offset:20736
    s_waitcnt lgkmcnt(8)
    v_mfma_f32_16x16x32_bf16 v[8:11], v[136:139], v[40:43], v[8:11]
    v_mfma_f32_16x16x32_bf16 v[12:15], v[136:139], v[44:47], v[12:15]
    ds_read_b128 v[40:43], v30 offset:22528
    ds_read_b128 v[44:47], v30 offset:22784
    s_waitcnt lgkmcnt(8)
    v_mfma_f32_16x16x32_bf16 v[8:11], v[140:143], v[48:51], v[8:11]
    v_mfma_f32_16x16x32_bf16 v[12:15], v[140:143], v[52:55], v[12:15]
    ds_read_b128 v[48:51], v30 offset:24576
    ds_read_b128 v[52:55], v30 offset:24832
    s_waitcnt lgkmcnt(8)
    v_mfma_f32_16x16x32_bf16 v[8:11], v[144:147], v[56:59], v[8:11]
    v_mfma_f32_16x16x32_bf16 v[12:15], v[144:147], v[60:63], v[12:15]
    ds_read_b128 v[56:59], v30 offset:26624
    ds_read_b128 v[60:63], v30 offset:26880
    s_waitcnt lgkmcnt(8)
    v_mfma_f32_16x16x32_bf16 v[8:11], v[148:151], v[64:67], v[8:11]
    v_mfma_f32_16x16x32_bf16 v[12:15], v[148:151], v[68:71], v[12:15]
    ds_read_b128 v[64:67], v30 offset:28672
    ds_read_b128 v[68:71], v30 offset:28928
    s_waitcnt lgkmcnt(8)
    v_mfma_f32_16x16x32_bf16 v[8:11], v[152:155], v[32:35], v[8:11]
    v_mfma_f32_16x16x32_bf16 v[12:15], v[152:155], v[36:39], v[12:15]
    ds_read_b128 v[32:35], v30 offset:30720
    ds_read_b128 v[36:39], v30 offset:30976
    s_waitcnt lgkmcnt(8)
    v_mfma_f32_16x16x32_bf16 v[8:11], v[156:159], v[40:43], v[8:11]
    v_mfma_f32_16x16x32_bf16 v[12:15], v[156:159], v[44:47], v[12:15]
    s_waitcnt lgkmcnt(6)
    v_mfma_f32_16x16x32_bf16 v[8:11], v[160:163], v[48:51], v[8:11]
    v_mfma_f32_16x16x32_bf16 v[12:15], v[160:163], v[52:55], v[12:15]
    s_waitcnt lgkmcnt(4)
    v_mfma_f32_16x16x32_bf16 v[8:11], v[164:167], v[56:59], v[8:11]
    v_mfma_f32_16x16x32_bf16 v[12:15], v[164:167], v[60:63], v[12:15]
    s_waitcnt lgkmcnt(2)
    v_mfma_f32_16x16x32_bf16 v[8:11], v[168:171], v[64:67], v[8:11]
    v_mfma_f32_16x16x32_bf16 v[12:15], v[168:171], v[68:71], v[12:15]
    s_waitcnt lgkmcnt(0)
    v_mfma_f32_16x16x32_bf16 v[8:11], v[172:175], v[32:35], v[8:11]
    v_mfma_f32_16x16x32_bf16 v[12:15], v[172:175], v[36:39], v[12:15]
    s_nop 7
    v_pk_add_f32 v[8:9], v[8:9], v[16:17]
    v_pk_add_f32 v[10:11], v[10:11], v[18:19]
    v_pk_add_f32 v[12:13], v[12:13], v[20:21]
    v_pk_add_f32 v[14:15], v[14:15], v[22:23]
    v_cvt_pk_bf16_f32 v40, v8, v9
    v_cvt_pk_bf16_f32 v41, v10, v11
    v_cvt_pk_bf16_f32 v42, v12, v13
    v_cvt_pk_bf16_f32 v43, v14, v15
    s_nop 1
    v_permlane16_swap_b32 v40, v42
    v_permlane16_swap_b32 v41, v43
    s_nop 1
    s_mov_b32 s55, s60
    buffer_store_dwordx4 v[40:43], v1, s[8:11], s60 offen sc1
    s_mov_b32 s61, 0x3f803f80
    v_mov_b32 v44, 0
    v_mov_b32 v45, 0
    v_dot2_f32_bf16 v44, v40, s61, v44
    v_dot2_f32_bf16 v45, v40, v40, v45
    v_dot2_f32_bf16 v44, v41, s61, v44
    v_dot2_f32_bf16 v45, v41, v41, v45
    v_dot2_f32_bf16 v44, v42, s61, v44
    v_dot2_f32_bf16 v45, v42, v42, v45
    v_dot2_f32_bf16 v44, v43, s61, v44
    v_dot2_f32_bf16 v45, v43, v43, v45
    s_nop 2
    v_mov_b32 v46, v44
    s_nop 1
    v_permlane32_swap_b32 v44, v46
    s_nop 1
    v_add_f32 v44, v44, v46
    v_mov_b32 v46, v45
    s_nop 1
    v_permlane32_swap_b32 v45, v46
    s_nop 1
    v_add_f32 v45, v45, v46
    s_lshl_b32 s60, s4, 8
    s_add_u32 s60, s60, 135168
    v_lshlrev_b32 v46, 3, v2
    v_add_u32 v47, s60, v46
    s_mov_b32 exec_hi, 0
    ds_write_b64 v47, v[44:45]
    s_mov_b64 exec, -1
    s_waitcnt lgkmcnt(0)
    s_lshl_b32 s60, s5, 4
    s_add_u32 s60, s60, s6
    s_lshl_b32 s60, s60, 7
    s_add_u32 s60, s60, 23527424
    v_mov_b32 v28, s56
    v_lshlrev_b32 v29, 2, v0
    s_waitcnt vmcnt(0)
    s_barrier
    s_cmp_lg_u32 s4, 0
    s_cbranch_scc1 pub_85
    s_mov_b32 exec_hi, 0
    s_cmp_eq_u32 s69, 1
    s_cbranch_scc1 gl_86
    buffer_store_dword v28, v29, s[8:11], s60 offen sc1
    s_branch ge_87
gl_86:
    buffer_store_dword v28, v29, s[8:11], s60 offen
ge_87:
    s_mov_b64 exec, -1
pub_85:
    s_cmp_eq_u32 s4, 7
    s_cbranch_scc1 nog_88
    s_add_u32 s75, s73, 0
    buffer_load_dwordx4 v[128:131], v1, s[8:11], s75 offen offset:0 sc1
    s_add_u32 s75, s73, 0
    buffer_load_dwordx4 v[132:135], v1, s[8:11], s75 offen offset:1024 sc1
    s_add_u32 s75, s73, 0
    buffer_load_dwordx4 v[136:139], v1, s[8:11], s75 offen offset:2048 sc1
    s_add_u32 s75, s73, 0
    buffer_load_dwordx4 v[140:143], v1, s[8:11], s75 offen offset:3072 sc1
    s_add_u32 s75, s73, 4096
    buffer_load_dwordx4 v[144:147], v1, s[8:11], s75 offen offset:0 sc1
    s_add_u32 s75, s73, 4096
    buffer_load_dwordx4 v[148:151], v1, s[8:11], s75 offen offset:1024 sc1
    s_add_u32 s75, s73, 4096
    buffer_load_dwordx4 v[152:155], v1, s[8:11], s75 offen offset:2048 sc1
    s_add_u32 s75, s73, 4096
    buffer_load_dwordx4 v[156:159], v1, s[8:11], s75 offen offset:3072 sc1
    s_add_u32 s75, s73, 8192
    buffer_load_dwordx4 v[160:163], v1, s[8:11], s75 offen offset:0 sc1
    s_add_u32 s75, s73, 8192
    buffer_load_dwordx4 v[164:167], v1, s[8:11], s75 offen offset:1024 sc1
    s_add_u32 s75, s73, 8192
    buffer_load_dwordx4 v[168:171], v1, s[8:11], s75 offen offset:2048 sc1
    s_add_u32 s75, s73, 8192
    buffer_load_dwordx4 v[172:175], v1, s[8:11], s75 offen offset:3072 sc1
nog_88:
    s_and_b32 s77, s6, 7
    s_mul_i32 s76, s77, 229376
    s_mul_i32 s60, s4, 14336
    s_add_u32 s76, s76, s60
    s_add_u32 s76, s76, 7405568
    s_lshl_b32 s62, s5, 17
    s_lshl_b32 s63, s4, 10
    s_add_u32 s62, s62, s63
    s_add_u32 s62, s62, 5242880
    s_cmp_lg_u32 s4, 7
    s_cbranch_scc1 wt_89
    s_lshl_b32 s60, s5, 4
    s_lshl_b32 s60, s60, 7
    s_add_u32 s60, s60, 23527424
    v_lshlrev_b32 v5, 7, v0
    s_mov_b64 exec, 0xffff
    s_mov_b32 s79, 400000
pl_91:
    buffer_load_dword v28, v5, s[8:11], s60 offen sc1
    s_waitcnt vmcnt(0)
    v_cmp_ne_u32 vcc, s56, v28
    s_nop 4
    s_cbranch_vccz pd_90
    s_sleep 1
    s_sub_u32 s79, s79, 1
    s_cmp_lg_u32 s79, 0
    s_cbranch_scc1 pl_91
pd_90:
    s_mov_b64 exec, -1
wt_89:
    s_barrier
    s_add_u32 m0, s63, 0
    s_add_u32 s64, s62, 0
    buffer_load_dwordx4 v1, s[8:11], s64 offen sc1 lds
    s_add_u32 m0, s63, 32768
    s_add_u32 s64, s62, 32768
    buffer_load_dwordx4 v1, s[8:11], s64 offen sc1 lds
    s_add_u32 m0, s63, 65536
    s_add_u32 s64, s62, 65536
    buffer_load_dwordx4 v1, s[8:11], s64 offen sc1 lds
    s_add_u32 m0, s63, 98304
    s_add_u32 s64, s62, 98304
    buffer_load_dwordx4 v1, s[8:11], s64 offen sc1 lds
    s_cmp_eq_u32 s4, 7
    s_cbranch_scc1 help_92
    v_add_u32 v2, 65536, v1
    s_waitcnt vmcnt(0)
    s_barrier
    ds_read_b128 v[32:35], v1 offset:0
    ds_read_b128 v[36:39], v1 offset:32768
    ds_read_b128 v[40:43], v2 offset:0
    ds_read_b128 v[44:47], v2 offset:32768
    s_add_u32 m0, s63, 8192
    s_add_u32 s64, s62, 8192
    buffer_load_dwordx4 v1, s[8:11], s64 offen sc1 lds
    s_add_u32 m0, s63, 40960
    s_add_u32 s64, s62, 40960
    buffer_load_dwordx4 v1, s[8:11], s64 offen sc1 lds
    s_add_u32 m0, s63, 73728
    s_add_u32 s64, s62, 73728
    buffer_load_dwordx4 v1, s[8:11], s64 offen sc1 lds
    s_add_u32 m0, s63, 106496
    s_add_u32 s64, s62, 106496
    buffer_load_dwordx4 v1, s[8:11], s64 offen sc1 lds
    ds_read_b128 v[48:51], v1 offset:1024
    ds_read_b128 v[52:55], v1 offset:33792
    ds_read_b128 v[56:59], v2 offset:1024
    ds_read_b128 v[60:63], v2 offset:33792
    s_setprio 3
    s_waitcnt lgkmcnt(4)
    v_mfma_f32_32x32x16_bf16 v[64:79], v[128:131], v[32:35], 0
    v_mfma_f32_32x32x16_bf16 v[80:95], v[128:131], v[36:39], 0
    v_mfma_f32_32x32x16_bf16 v[96:111], v[128:131], v[40:43], 0
    v_mfma_f32_32x32x16_bf16 v[112:127], v[128:131], v[44:47], 0
    ds_read_b128 v[32:35], v1 offset:2048
    ds_read_b128 v[36:39], v1 offset:34816
    ds_read_b128 v[40:43], v2 offset:2048
    ds_read_b128 v[44:47], v2 offset:34816
    s_waitcnt lgkmcnt(4)
    v_mfma_f32_32x32x16_bf16 v[64:79], v[132:135], v[48:51], v[64:79]
    v_mfma_f32_32x32x16_bf16 v[80:95], v[132:135], v[52:55], v[80:95]
    v_mfma_f32_32x32x16_bf16 v[96:111], v[132:135], v[56:59], v[96:111]
    v_mfma_f32_32x32x16_bf16 v[112:127], v[132:135], v[60:63], v[112:127]
    s_add_u32 s75, s76, 0
    buffer_load_dwordx4 v[128:131], v1, s[8:11], s75 offen offset:0 sc1
    ds_read_b128 v[48:51], v1 offset:3072
    ds_read_b128 v[52:55], v1 offset:35840
    ds_read_b128 v[56:59], v2 offset:3072
    ds_read_b128 v[60:63], v2 offset:35840
    s_setprio 2
    s_waitcnt lgkmcnt(4)
    v_mfma_f32_32x32x16_bf16 v[64:79], v[136:139], v[32:35], v[64:79]
    v_mfma_f32_32x32x16_bf16 v[80:95], v[136:139], v[36:39], v[80:95]
    v_mfma_f32_32x32x16_bf16 v[96:111], v[136:139], v[40:43], v[96:111]
    v_mfma_f32_32x32x16_bf16 v[112:127], v[136:139], v[44:47], v[112:127]
    s_add_u32 m0, s63, 16384
    s_add_u32 s64, s62, 16384
    buffer_load_dwordx4 v1, s[8:11], s64 offen sc1 lds
    s_add_u32 m0, s63, 49152
    s_add_u32 s64, s62, 49152
    buffer_load_dwordx4 v1, s[8:11], s64 offen sc1 lds
    s_add_u32 m0, s63, 81920
    s_add_u32 s64, s62, 81920
    buffer_load_dwordx4 v1, s[8:11], s64 offen sc1 lds
    s_add_u32 m0, s63, 114688
    s_add_u32 s64, s62, 114688
    buffer_load_dwordx4 v1, s[8:11], s64 offen sc1 lds
    s_add_u32 s75, s76, 114688
    buffer_load_dwordx4 v[132:135], v1, s[8:11], s75 offen offset:0 sc1
    ds_read_b128 v[32:35], v1 offset:4096
    ds_read_b128 v[36:39], v1 offset:36864
    ds_read_b128 v[40:43], v2 offset:4096
    ds_read_b128 v[44:47], v2 offset:36864
    s_waitcnt lgkmcnt(4)
    v_mfma_f32_32x32x16_bf16 v[64:79], v[140:143], v[48:51], v[64:79]
    v_mfma_f32_32x32x16_bf16 v[80:95], v[140:143], v[52:55], v[80:95]
    v_mfma_f32_32x32x16_bf16 v[96:111], v[140:143], v[56:59], v[96:111]
    v_mfma_f32_32x32x16_bf16 v[112:127], v[140:143], v[60:63], v[112:127]
    s_add_u32 s75, s76, 0
    buffer_load_dwordx4 v[136:139], v1, s[8:11], s75 offen offset:1024 sc1
    ds_read_b128 v[48:51], v1 offset:5120
    ds_read_b128 v[52:55], v1 offset:37888
    ds_read_b128 v[56:59], v2 offset:5120
    ds_read_b128 v[60:63], v2 offset:37888
    s_setprio 1
    s_waitcnt lgkmcnt(4)
    v_mfma_f32_32x32x16_bf16 v[64:79], v[144:147], v[32:35], v[64:79]
    v_mfma_f32_32x32x16_bf16 v[80:95], v[144:147], v[36:39], v[80:95]
    v_mfma_f32_32x32x16_bf16 v[96:111], v[144:147], v[40:43], v[96:111]
    v_mfma_f32_32x32x16_bf16 v[112:127], v[144:147], v[44:47], v[112:127]
    s_add_u32 s75, s76, 114688
    buffer_load_dwordx4 v[140:143], v1, s[8:11], s75 offen offset:1024 sc1
    ds_read_b128 v[32:35], v1 offset:6144
    ds_read_b128 v[36:39], v1 offset:38912
    ds_read_b128 v[40:43], v2 offset:6144
    ds_read_b128 v[44:47], v2 offset:38912
    s_waitcnt lgkmcnt(4)
    v_mfma_f32_32x32x16_bf16 v[64:79], v[148:151], v[48:51], v[64:79]
    v_mfma_f32_32x32x16_bf16 v[80:95], v[148:151], v[52:55], v[80:95]
    v_mfma_f32_32x32x16_bf16 v[96:111], v[148:151], v[56:59], v[96:111]
    v_mfma_f32_32x32x16_bf16 v[112:127], v[148:151], v[60:63], v[112:127]
    s_add_u32 s75, s76, 0
    buffer_load_dwordx4 v[144:147], v1, s[8:11], s75 offen offset:2048 sc1
    ds_read_b128 v[48:51], v1 offset:7168
    ds_read_b128 v[52:55], v1 offset:39936
    ds_read_b128 v[56:59], v2 offset:7168
    ds_read_b128 v[60:63], v2 offset:39936
    s_setprio 0
    s_waitcnt lgkmcnt(4)
    v_mfma_f32_32x32x16_bf16 v[64:79], v[152:155], v[32:35], v[64:79]
    v_mfma_f32_32x32x16_bf16 v[80:95], v[152:155], v[36:39], v[80:95]
    v_mfma_f32_32x32x16_bf16 v[96:111], v[152:155], v[40:43], v[96:111]
    v_mfma_f32_32x32x16_bf16 v[112:127], v[152:155], v[44:47], v[112:127]
    s_add_u32 m0, s63, 24576
    s_add_u32 s64, s62, 24576
    buffer_load_dwordx4 v1, s[8:11], s64 offen sc1 lds
    s_add_u32 m0, s63, 57344
    s_add_u32 s64, s62, 57344
    buffer_load_dwordx4 v1, s[8:11], s64 offen sc1 lds
    s_add_u32 m0, s63, 90112
    s_add_u32 s64, s62, 90112
    buffer_load_dwordx4 v1, s[8:11], s64 offen sc1 lds
    s_add_u32 m0, s63, 122880
    s_add_u32 s64, s62, 122880
    buffer_load_dwordx4 v1, s[8:11], s64 offen sc1 lds
    s_add_u32 s75, s76, 114688
    buffer_load_dwordx4 v[148:151], v1, s[8:11], s75 offen offset:2048 sc1
    s_waitcnt vmcnt(14)
    s_barrier
    ds_read_b128 v[32:35], v1 offset:8192
    ds_read_b128 v[36:39], v1 offset:40960
    ds_read_b128 v[40:43], v2 offset:8192
    ds_read_b128 v[44:47], v2 offset:40960
    s_waitcnt lgkmcnt(4)
    v_mfma_f32_32x32x16_bf16 v[64:79], v[156:159], v[48:51], v[64:79]
    v_mfma_f32_32x32x16_bf16 v[80:95], v[156:159], v[52:55], v[80:95]
    v_mfma_f32_32x32x16_bf16 v[96:111], v[156:159], v[56:59], v[96:111]
    v_mfma_f32_32x32x16_bf16 v[112:127], v[156:159], v[60:63], v[112:127]
    s_add_u32 s75, s76, 0
    buffer_load_dwordx4 v[152:155], v1, s[8:11], s75 offen offset:3072 sc1
    ds_read_b128 v[48:51], v1 offset:9216
    ds_read_b128 v[52:55], v1 offset:41984
    ds_read_b128 v[56:59], v2 offset:9216
    ds_read_b128 v[60:63], v2 offset:41984
    s_setprio 3
    s_waitcnt lgkmcnt(4)
    v_mfma_f32_32x32x16_bf16 v[64:79], v[160:163], v[32:35], v[64:79]
    v_mfma_f32_32x32x16_bf16 v[80:95], v[160:163], v[36:39], v[80:95]
    v_mfma_f32_32x32x16_bf16 v[96:111], v[160:163], v[40:43], v[96:111]
    v_mfma_f32_32x32x16_bf16 v[112:127], v[160:163], v[44:47], v[112:127]
    s_add_u32 s75, s76, 114688
    buffer_load_dwordx4 v[156:159], v1, s[8:11], s75 offen offset:3072 sc1
    ds_read_b128 v[32:35], v1 offset:10240
    ds_read_b128 v[36:39], v1 offset:43008
    ds_read_b128 v[40:43], v2 offset:10240
    ds_read_b128 v[44:47], v2 offset:43008
    s_waitcnt lgkmcnt(4)
    v_mfma_f32_32x32x16_bf16 v[64:79], v[164:167], v[48:51], v[64:79]
    v_mfma_f32_32x32x16_bf16 v[80:95], v[164:167], v[52:55], v[80:95]
    v_mfma_f32_32x32x16_bf16 v[96:111], v[164:167], v[56:59], v[96:111]
    v_mfma_f32_32x32x16_bf16 v[112:127], v[164:167], v[60:63], v[112:127]
    s_add_u32 s75, s76, 4096
    buffer_load_dwordx4 v[160:163], v1, s[8:11], s75 offen offset:0 sc1
    ds_read_b128 v[48:51], v1 offset:11264
    ds_read_b128 v[52:55], v1 offset:44032
    ds_read_b128 v[56:59], v2 offset:11264
    ds_read_b128 v[60:63], v2 offset:44032
    s_setprio 2
    s_waitcnt lgkmcnt(4)
    v_mfma_f32_32x32x16_bf16 v[64:79], v[168:171], v[32:35], v[64:79]
    v_mfma_f32_32x32x16_bf16 v[80:95], v[168:171], v[36:39], v[80:95]
    v_mfma_f32_32x32x16_bf16 v[96:111], v[168:171], v[40:43], v[96:111]
    v_mfma_f32_32x32x16_bf16 v[112:127], v[168:171], v[44:47], v[112:127]
    s_add_u32 s75, s76, 118784
    buffer_load_dwordx4 v[164:167], v1, s[8:11], s75 offen offset:0 sc1
    ds_read_b128 v[32:35], v1 offset:12288
    ds_read_b128 v[36:39], v1 offset:45056
    ds_read_b128 v[40:43], v2 offset:12288
    ds_read_b128 v[44:47], v2 offset:45056
    s_waitcnt lgkmcnt(4)
    v_mfma_f32_32x32x16_bf16 v[64:79], v[172:175], v[48:51], v[64:79]
    v_mfma_f32_32x32x16_bf16 v[80:95], v[172:175], v[52:55], v[80:95]
    v_mfma_f32_32x32x16_bf16 v[96:111], v[172:175], v[56:59], v[96:111]
    v_mfma_f32_32x32x16_bf16 v[112:127], v[172:175], v[60:63], v[112:127]
    s_add_u32 s75, s76, 4096
    buffer_load_dwordx4 v[168:171], v1, s[8:11], s75 offen offset:1024 sc1
    ds_read_b128 v[48:51], v1 offset:13312
    ds_read_b128 v[52:55], v1 offset:46080
    ds_read_b128 v[56:59], v2 offset:13312
    ds_read_b128 v[60:63], v2 offset:46080
    s_setprio 1
    s_waitcnt lgkmcnt(4)
    v_mfma_f32_32x32x16_bf16 v[64:79], v[176:179], v[32:35], v[64:79]
    v_mfma_f32_32x32x16_bf16 v[80:95], v[176:179], v[36:39], v[80:95]
    v_mfma_f32_32x32x16_bf16 v[96:111], v[176:179], v[40:43], v[96:111]
    v_mfma_f32_32x32x16_bf16 v[112:127], v[176:179], v[44:47], v[112:127]
    s_add_u32 s75, s76, 118784
    buffer_load_dwordx4 v[172:175], v1, s[8:11], s75 offen offset:1024 sc1
    ds_read_b128 v[32:35], v1 offset:14336
    ds_read_b128 v[36:39], v1 offset:47104
    ds_read_b128 v[40:43], v2 offset:14336
    ds_read_b128 v[44:47], v2 offset:47104
    s_waitcnt lgkmcnt(4)
    v_mfma_f32_32x32x16_bf16 v[64:79], v[180:183], v[48:51], v[64:79]
    v_mfma_f32_32x32x16_bf16 v[80:95], v[180:183], v[52:55], v[80:95]
    v_mfma_f32_32x32x16_bf16 v[96:111], v[180:183], v[56:59], v[96:111]
    v_mfma_f32_32x32x16_bf16 v[112:127], v[180:183], v[60:63], v[112:127]
    s_add_u32 s75, s76, 4096
    buffer_load_dwordx4 v[176:179], v1, s[8:11], s75 offen offset:2048 sc1
    ds_read_b128 v[48:51], v1 offset:15360
    ds_read_b128 v[52:55], v1 offset:48128
    ds_read_b128 v[56:59], v2 offset:15360
    ds_read_b128 v[60:63], v2 offset:48128
    s_setprio 0
    s_waitcnt lgkmcnt(4)
    v_mfma_f32_32x32x16_bf16 v[64:79], v[184:187], v[32:35], v[64:79]
    v_mfma_f32_32x32x16_bf16 v[80:95], v[184:187], v[36:39], v[80:95]
    v_mfma_f32_32x32x16_bf16 v[96:111], v[184:187], v[40:43], v[96:111]
    v_mfma_f32_32x32x16_bf16 v[112:127], v[184:187], v[44:47], v[112:127]
    s_add_u32 s75, s76, 118784
    buffer_load_dwordx4 v[180:183], v1, s[8:11], s75 offen offset:2048 sc1
    s_waitcnt vmcnt(17)
    s_barrier
    ds_read_b128 v[32:35], v1 offset:16384
    ds_read_b128 v[36:39], v1 offset:49152
    ds_read_b128 v[40:43], v2 offset:16384
    ds_read_b128 v[44:47], v2 offset:49152
    s_waitcnt lgkmcnt(4)
    v_mfma_f32_32x32x16_bf16 v[64:79], v[188:191], v[48:51], v[64:79]
    v_mfma_f32_32x32x16_bf16 v[80:95], v[188:191], v[52:55], v[80:95]
    v_mfma_f32_32x32x16_bf16 v[96:111], v[188:191], v[56:59], v[96:111]
    v_mfma_f32_32x32x16_bf16 v[112:127], v[188:191], v[60:63], v[112:127]
    s_add_u32 s75, s76, 4096
    buffer_load_dwordx4 v[184:187], v1, s[8:11], s75 offen offset:3072 sc1
    ds_read_b128 v[48:51], v1 offset:17408
    ds_read_b128 v[52:55], v1 offset:50176
    ds_read_b128 v[56:59], v2 offset:17408
    ds_read_b128 v[60:63], v2 offset:50176
    s_setprio 3
    s_waitcnt lgkmcnt(4)
    v_mfma_f32_32x32x16_bf16 v[64:79], v[192:195], v[32:35], v[64:79]
    v_mfma_f32_32x32x16_bf16 v[80:95], v[192:195], v[36:39], v[80:95]
    v_mfma_f32_32x32x16_bf16 v[96:111], v[192:195], v[40:43], v[96:111]
    v_mfma_f32_32x32x16_bf16 v[112:127], v[192:195], v[44:47], v[112:127]
    s_add_u32 s75, s76, 118784
    buffer_load_dwordx4 v[188:191], v1, s[8:11], s75 offen offset:3072 sc1
    ds_read_b128 v[32:35], v1 offset:18432
    ds_read_b128 v[36:39], v1 offset:51200
    ds_read_b128 v[40:43], v2 offset:18432
    ds_read_b128 v[44:47], v2 offset:51200
    s_waitcnt lgkmcnt(4)
    v_mfma_f32_32x32x16_bf16 v[64:79], v[196:199], v[48:51], v[64:79]
    v_mfma_f32_32x32x16_bf16 v[80:95], v[196:199], v[52:55], v[80:95]
    v_mfma_f32_32x32x16_bf16 v[96:111], v[196:199], v[56:59], v[96:111]
    v_mfma_f32_32x32x16_bf16 v[112:127], v[196:199], v[60:63], v[112:127]
    s_add_u32 s75, s76, 8192
    buffer_load_dwordx4 v[192:195], v1, s[8:11], s75 offen offset:0 sc1
    ds_read_b128 v[48:51], v1 offset:19456
    ds_read_b128 v[52:55], v1 offset:52224
    ds_read_b128 v[56:59], v2 offset:19456
    ds_read_b128 v[60:63], v2 offset:52224
    s_setprio 2
    s_waitcnt lgkmcnt(4)
    v_mfma_f32_32x32x16_bf16 v[64:79], v[200:203], v[32:35], v[64:79]
    v_mfma_f32_32x32x16_bf16 v[80:95], v[200:203], v[36:39], v[80:95]
    v_mfma_f32_32x32x16_bf16 v[96:111], v[200:203], v[40:43], v[96:111]
    v_mfma_f32_32x32x16_bf16 v[112:127], v[200:203], v[44:47], v[112:127]
    s_add_u32 s75, s76, 122880
    buffer_load_dwordx4 v[196:199], v1, s[8:11], s75 offen offset:0 sc1
    ds_read_b128 v[32:35], v1 offset:20480
    ds_read_b128 v[36:39], v1 offset:53248
    ds_read_b128 v[40:43], v2 offset:20480
    ds_read_b128 v[44:47], v2 offset:53248
    s_waitcnt lgkmcnt(4)
    v_mfma_f32_32x32x16_bf16 v[64:79], v[204:207], v[48:51], v[64:79]
    v_mfma_f32_32x32x16_bf16 v[80:95], v[204:207], v[52:55], v[80:95]
    v_mfma_f32_32x32x16_bf16 v[96:111], v[204:207], v[56:59], v[96:111]
    v_mfma_f32_32x32x16_bf16 v[112:127], v[204:207], v[60:63], v[112:127]
    s_add_u32 s75, s76, 8192
    buffer_load_dwordx4 v[200:203], v1, s[8:11], s75 offen offset:1024 sc1
    ds_read_b128 v[48:51], v1 offset:21504
    ds_read_b128 v[52:55], v1 offset:54272
    ds_read_b128 v[56:59], v2 offset:21504
    ds_read_b128 v[60:63], v2 offset:54272
    s_setprio 1
    s_waitcnt lgkmcnt(4)
    v_mfma_f32_32x32x16_bf16 v[64:79], v[208:211], v[32:35], v[64:79]
    v_mfma_f32_32x32x16_bf16 v[80:95], v[208:211], v[36:39], v[80:95]
    v_mfma_f32_32x32x16_bf16 v[96:111], v[208:211], v[40:43], v[96:111]
    v_mfma_f32_32x32x16_bf16 v[112:127], v[208:211], v[44:47], v[112:127]
    s_add_u32 s75, s76, 122880
    buffer_load_dwordx4 v[204:207], v1, s[8:11], s75 offen offset:1024 sc1
    ds_read_b128 v[32:35], v1 offset:22528
    ds_read_b128 v[36:39], v1 offset:55296
    ds_read_b128 v[40:43], v2 offset:22528
    ds_read_b128 v[44:47], v2 offset:55296
    s_waitcnt lgkmcnt(4)
    v_mfma_f32_32x32x16_bf16 v[64:79], v[212:215], v[48:51], v[64:79]
    v_mfma_f32_32x32x16_bf16 v[80:95], v[212:215], v[52:55], v[80:95]
    v_mfma_f32_32x32x16_bf16 v[96:111], v[212:215], v[56:59], v[96:111]
    v_mfma_f32_32x32x16_bf16 v[112:127], v[212:215], v[60:63], v[112:127]
    s_add_u32 s75, s76, 8192
    buffer_load_dwordx4 v[208:211], v1, s[8:11], s75 offen offset:2048 sc1
    ds_read_b128 v[48:51], v1 offset:23552
    ds_read_b128 v[52:55], v1 offset:56320
    ds_read_b128 v[56:59], v2 offset:23552
    ds_read_b128 v[60:63], v2 offset:56320
    s_setprio 0
    s_waitcnt lgkmcnt(4)
    v_mfma_f32_32x32x16_bf16 v[64:79], v[216:219], v[32:35], v[64:79]
    v_mfma_f32_32x32x16_bf16 v[80:95], v[216:219], v[36:39], v[80:95]
    v_mfma_f32_32x32x16_bf16 v[96:111], v[216:219], v[40:43], v[96:111]
    v_mfma_f32_32x32x16_bf16 v[112:127], v[216:219], v[44:47], v[112:127]
    s_add_u32 s75, s76, 122880
    buffer_load_dwordx4 v[212:215], v1, s[8:11], s75 offen offset:2048 sc1
    s_waitcnt vmcnt(17)
    s_barrier
    s_waitcnt lgkmcnt(0)
    v_mfma_f32_32x32x16_bf16 v[64:79], v[220:223], v[48:51], v[64:79]
    v_mfma_f32_32x32x16_bf16 v[80:95], v[220:223], v[52:55], v[80:95]
    v_mfma_f32_32x32x16_bf16 v[96:111], v[220:223], v[56:59], v[96:111]
    v_mfma_f32_32x32x16_bf16 v[112:127], v[220:223], v[60:63], v[112:127]
    s_add_u32 s75, s76, 8192
    buffer_load_dwordx4 v[216:219], v1, s[8:11], s75 offen offset:3072 sc1
    v_and_b32 v3, 31, v0
    v_lshlrev_b32 v3, 3, v3
    v_add_u32 v3, 131072, v3
    ds_read_b128 v[32:35], v1 offset:24576
    ds_read_b128 v[36:39], v1 offset:25600
    ds_read_b128 v[40:43], v1 offset:26624
    ds_read_b128 v[44:47], v1 offset:27648
    ds_read_b64 v[4:5], v3 offset:0
    ds_read_b64 v[6:7], v3 offset:256
    ds_read_b64 v[8:9], v3 offset:512
    ds_read_b64 v[10:11], v3 offset:768
    v_lshrrev_b32 v12, 5, v0
    v_lshlrev_b32 v12, 4, v12
    s_lshl_b32 s60, s4, 7
    s_add_u32 s60, s60, 132096
    v_add_u32 v12, s60, v12
    ds_read_b128 v[16:19], v12 offset:0
    ds_read_b128 v[20:23], v12 offset:32
    ds_read_b128 v[24:27], v12 offset:64
    ds_read_b128 v[28:31], v12 offset:96
    s_mul_i32 s60, s74, 1024
    s_lshl_b32 s61, s5, 19
    s_add_u32 s60, s60, s61
    s_add_u32 s60, s60, 13631488
    ds_read_b128 v[48:51], v1 offset:28672
    s_waitcnt lgkmcnt(12)
    v_mfma_f32_32x32x16_bf16 v[64:79], v[224:227], v[32:35], v[64:79]
    s_add_u32 s75, s76, 122880
    buffer_load_dwordx4 v[220:223], v1, s[8:11], s75 offen offset:3072 sc1
    ds_read_b128 v[52:55], v1 offset:29696
    s_waitcnt lgkmcnt(12)
    v_mfma_f32_32x32x16_bf16 v[64:79], v[228:231], v[36:39], v[64:79]
    ds_read_b128 v[56:59], v1 offset:30720
    s_waitcnt lgkmcnt(12)
    v_mfma_f32_32x32x16_bf16 v[64:79], v[232:235], v[40:43], v[64:79]
    ds_read_b128 v[60:63], v1 offset:31744
    s_waitcnt lgkmcnt(12)
    v_mfma_f32_32x32x16_bf16 v[64:79], v[236:239], v[44:47], v[64:79]
    ds_read_b128 v[32:35], v1 offset:57344
    s_waitcnt lgkmcnt(4)
    v_mfma_f32_32x32x16_bf16 v[64:79], v[240:243], v[48:51], v[64:79]
    ds_read_b128 v[36:39], v1 offset:58368
    s_waitcnt lgkmcnt(4)
    v_mfma_f32_32x32x16_bf16 v[64:79], v[244:247], v[52:55], v[64:79]
    ds_read_b128 v[40:43], v1 offset:59392
    s_waitcnt lgkmcnt(4)
    v_mfma_f32_32x32x16_bf16 v[64:79], v[248:251], v[56:59], v[64:79]
    ds_read_b128 v[44:47], v1 offset:60416
    s_waitcnt lgkmcnt(4)
    v_mfma_f32_32x32x16_bf16 v[64:79], v[252:255], v[60:63], v[64:79]
    ds_read_b128 v[48:51], v1 offset:61440
    s_waitcnt lgkmcnt(4)
    v_mfma_f32_32x32x16_bf16 v[80:95], v[224:227], v[32:35], v[80:95]
    ds_read_b128 v[52:55], v1 offset:62464
    s_waitcnt lgkmcnt(4)
    v_mfma_f32_32x32x16_bf16 v[80:95], v[228:231], v[36:39], v[80:95]
    ds_read_b128 v[56:59], v1 offset:63488
    s_waitcnt lgkmcnt(4)
    v_mfma_f32_32x32x16_bf16 v[80:95], v[232:235], v[40:43], v[80:95]
    s_nop 3
    v_pk_fma_f32 v[64:65], v[16:17], v[4:5], v[64:65] op_sel_hi:[1,0,1]
    v_pk_fma_f32 v[66:67], v[18:19], v[4:5], v[66:67] op_sel_hi:[1,0,1]
    v_pk_fma_f32 v[68:69], v[20:21], v[4:5], v[68:69] op_sel_hi:[1,0,1]
    v_pk_fma_f32 v[70:71], v[22:23], v[4:5], v[70:71] op_sel_hi:[1,0,1]
    v_pk_fma_f32 v[72:73], v[24:25], v[4:5], v[72:73] op_sel_hi:[1,0,1]
    ds_read_b128 v[60:63], v1 offset:64512
    s_waitcnt lgkmcnt(4)
    v_mfma_f32_32x32x16_bf16 v[80:95], v[236:239], v[44:47], v[80:95]
    v_pk_fma_f32 v[74:75], v[26:27], v[4:5], v[74:75] op_sel_hi:[1,0,1]
    v_pk_fma_f32 v[76:77], v[28:29], v[4:5], v[76:77] op_sel_hi:[1,0,1]
    v_pk_fma_f32 v[78:79], v[30:31], v[4:5], v[78:79] op_sel_hi:[1,0,1]
    v_pk_mul_f32 v[72:73], v[72:73], v[4:5] op_sel:[0,1] op_sel_hi:[1,1]
    v_pk_mul_f32 v[74:75], v[74:75], v[4:5] op_sel:[0,1] op_sel_hi:[1,1]
    ds_read_b128 v[32:35], v2 offset:24576
    s_waitcnt lgkmcnt(4)
    v_mfma_f32_32x32x16_bf16 v[80:95], v[240:243], v[48:51], v[80:95]
    v_pk_mul_f32 v[76:77], v[76:77], v[4:5] op_sel:[0,1] op_sel_hi:[1,1]
    v_pk_mul_f32 v[78:79], v[78:79], v[4:5] op_sel:[0,1] op_sel_hi:[1,1]
    v_max_f32 v64, 0, v64
    v_max_f32 v65, 0, v65
    v_max_f32 v66, 0, v66
    ds_read_b128 v[36:39], v2 offset:25600
    s_waitcnt lgkmcnt(4)
    v_mfma_f32_32x32x16_bf16 v[80:95], v[244:247], v[52:55], v[80:95]
    v_max_f32 v67, 0, v67
    v_max_f32 v68, 0, v68
    v_max_f32 v69, 0, v69
    v_max_f32 v70, 0, v70
    v_max_f32 v71, 0, v71
    ds_read_b128 v[40:43], v2 offset:26624
    s_waitcnt lgkmcnt(4)
    v_mfma_f32_32x32x16_bf16 v[80:95], v[248:251], v[56:59], v[80:95]
    v_pk_mul_f32 v[64:65], v[64:65], v[72:73]
    v_pk_mul_f32 v[66:67], v[66:67], v[74:75]
    v_pk_mul_f32 v[68:69], v[68:69], v[76:77]
    v_pk_mul_f32 v[70:71], v[70:71], v[78:79]
    v_cvt_pk_bf16_f32 v72, v64, v65
    ds_read_b128 v[44:47], v2 offset:27648
    s_waitcnt lgkmcnt(4)
    v_mfma_f32_32x32x16_bf16 v[80:95], v[252:255], v[60:63], v[80:95]
    v_cvt_pk_bf16_f32 v73, v66, v67
    v_cvt_pk_bf16_f32 v74, v68, v69
    v_cvt_pk_bf16_f32 v75, v70, v71
    buffer_store_dwordx4 v[72:75], v1, s[8:11], s60 offen sc1
    s_add_u32 s60, s60, 114688
    ds_read_b128 v[48:51], v2 offset:28672
    s_waitcnt lgkmcnt(4)
    v_mfma_f32_32x32x16_bf16 v[96:111], v[224:227], v[32:35], v[96:111]
    ds_read_b128 v[52:55], v2 offset:29696
    s_waitcnt lgkmcnt(4)
    v_mfma_f32_32x32x16_bf16 v[96:111], v[228:231], v[36:39], v[96:111]
    ds_read_b128 v[56:59], v2 offset:30720
    s_waitcnt lgkmcnt(4)
    v_mfma_f32_32x32x16_bf16 v[96:111], v[232:235], v[40:43], v[96:111]
    s_nop 3
    v_pk_fma_f32 v[80:81], v[16:17], v[6:7], v[80:81] op_sel_hi:[1,0,1]
    v_pk_fma_f32 v[82:83], v[18:19], v[6:7], v[82:83] op_sel_hi:[1,0,1]
    v_pk_fma_f32 v[84:85], v[20:21], v[6:7], v[84:85] op_sel_hi:[1,0,1]
    v_pk_fma_f32 v[86:87], v[22:23], v[6:7], v[86:87] op_sel_hi:[1,0,1]
    v_pk_fma_f32 v[88:89], v[24:25], v[6:7], v[88:89] op_sel_hi:[1,0,1]
    ds_read_b128 v[60:63], v2 offset:31744
    s_waitcnt lgkmcnt(4)
    v_mfma_f32_32x32x16_bf16 v[96:111], v[236:239], v[44:47], v[96:111]
    v_pk_fma_f32 v[90:91], v[26:27], v[6:7], v[90:91] op_sel_hi:[1,0,1]
    v_pk_fma_f32 v[92:93], v[28:29], v[6:7], v[92:93] op_sel_hi:[1,0,1]
    v_pk_fma_f32 v[94:95], v[30:31], v[6:7], v[94:95] op_sel_hi:[1,0,1]
    v_pk_mul_f32 v[88:89], v[88:89], v[6:7] op_sel:[0,1] op_sel_hi:[1,1]
    v_pk_mul_f32 v[90:91], v[90:91], v[6:7] op_sel:[0,1] op_sel_hi:[1,1]
    ds_read_b128 v[32:35], v2 offset:57344
    s_waitcnt lgkmcnt(4)
    v_mfma_f32_32x32x16_bf16 v[96:111], v[240:243], v[48:51], v[96:111]
    v_pk_mul_f32 v[92:93], v[92:93], v[6:7] op_sel:[0,1] op_sel_hi:[1,1]
    v_pk_mul_f32 v[94:95], v[94:95], v[6:7] op_sel:[0,1] op_sel_hi:[1,1]
    v_max_f32 v80, 0, v80
    v_max_f32 v81, 0, v81
    v_max_f32 v82, 0, v82
    ds_read_b128 v[36:39], v2 offset:58368
    s_waitcnt lgkmcnt(4)
    v_mfma_f32_32x32x16_bf16 v[96:111], v[244:247], v[52:55], v[96:111]
    v_max_f32 v83, 0, v83
    v_max_f32 v84, 0, v84
    v_max_f32 v85, 0, v85
    v_max_f32 v86, 0, v86
    v_max_f32 v87, 0, v87
    ds_read_b128 v[40:43], v2 offset:59392
    s_waitcnt lgkmcnt(4)
    v_mfma_f32_32x32x16_bf16 v[96:111], v[248:251], v[56:59], v[96:111]
    v_pk_mul_f32 v[80:81], v[80:81], v[88:89]
    v_pk_mul_f32 v[82:83], v[82:83], v[90:91]
    v_pk_mul_f32 v[84:85], v[84:85], v[92:93]
    v_pk_mul_f32 v[86:87], v[86:87], v[94:95]
    v_cvt_pk_bf16_f32 v88, v80, v81
    ds_read_b128 v[44:47], v2 offset:60416
    s_waitcnt lgkmcnt(4)
    v_mfma_f32_32x32x16_bf16 v[96:111], v[252:255], v[60:63], v[96:111]
    v_cvt_pk_bf16_f32 v89, v82, v83
    v_cvt_pk_bf16_f32 v90, v84, v85
    v_cvt_pk_bf16_f32 v91, v86, v87
    buffer_store_dwordx4 v[88:91], v1, s[8:11], s60 offen sc1
    s_add_u32 s60, s60, 114688
    ds_read_b128 v[48:51], v2 offset:61440
    s_waitcnt lgkmcnt(4)
    v_mfma_f32_32x32x16_bf16 v[112:127], v[224:227], v[32:35], v[112:127]
    ds_read_b128 v[52:55], v2 offset:62464
    s_waitcnt lgkmcnt(4)
    v_mfma_f32_32x32x16_bf16 v[112:127], v[228:231], v[36:39], v[112:127]
    ds_read_b128 v[56:59], v2 offset:63488
    s_waitcnt lgkmcnt(4)
    v_mfma_f32_32x32x16_bf16 v[112:127], v[232:235], v[40:43], v[112:127]
    s_nop 3
    v_pk_fma_f32 v[96:97], v[16:17], v[8:9], v[96:97] op_sel_hi:[1,0,1]
    v_pk_fma_f32 v[98:99], v[18:19], v[8:9], v[98:99] op_sel_hi:[1,0,1]
    v_pk_fma_f32 v[100:101], v[20:21], v[8:9], v[100:101] op_sel_hi:[1,0,1]
    v_pk_fma_f32 v[102:103], v[22:23], v[8:9], v[102:103] op_sel_hi:[1,0,1]
    v_pk_fma_f32 v[104:105], v[24:25], v[8:9], v[104:105] op_sel_hi:[1,0,1]
    ds_read_b128 v[60:63], v2 offset:64512
    s_waitcnt lgkmcnt(4)
    v_mfma_f32_32x32x16_bf16 v[112:127], v[236:239], v[44:47], v[112:127]
    v_pk_fma_f32 v[106:107], v[26:27], v[8:9], v[106:107] op_sel_hi:[1,0,1]
    v_pk_fma_f32 v[108:109], v[28:29], v[8:9], v[108:109] op_sel_hi:[1,0,1]
    v_pk_fma_f32 v[110:111], v[30:31], v[8:9], v[110:111] op_sel_hi:[1,0,1]
    v_pk_mul_f32 v[104:105], v[104:105], v[8:9] op_sel:[0,1] op_sel_hi:[1,1]
    v_pk_mul_f32 v[106:107], v[106:107], v[8:9] op_sel:[0,1] op_sel_hi:[1,1]
    s_waitcnt lgkmcnt(3)
    v_mfma_f32_32x32x16_bf16 v[112:127], v[240:243], v[48:51], v[112:127]
    v_pk_mul_f32 v[108:109], v[108:109], v[8:9] op_sel:[0,1] op_sel_hi:[1,1]
    v_pk_mul_f32 v[110:111], v[110:111], v[8:9] op_sel:[0,1] op_sel_hi:[1,1]
    v_max_f32 v96, 0, v96
    v_max_f32 v97, 0, v97
    v_max_f32 v98, 0, v98
    s_waitcnt lgkmcnt(2)
    v_mfma_f32_32x32x16_bf16 v[112:127], v[244:247], v[52:55], v[112:127]
    v_max_f32 v99, 0, v99
    v_max_f32 v100, 0, v100
    v_max_f32 v101, 0, v101
    v_max_f32 v102, 0, v102
    v_max_f32 v103, 0, v103
    s_waitcnt lgkmcnt(1)
    v_mfma_f32_32x32x16_bf16 v[112:127], v[248:251], v[56:59], v[112:127]
    v_pk_mul_f32 v[96:97], v[96:97], v[104:105]
    v_pk_mul_f32 v[98:99], v[98:99], v[106:107]
    v_pk_mul_f32 v[100:101], v[100:101], v[108:109]
    v_pk_mul_f32 v[102:103], v[102:103], v[110:111]
    v_cvt_pk_bf16_f32 v104, v96, v97
    s_waitcnt lgkmcnt(0)
    v_mfma_f32_32x32x16_bf16 v[112:127], v[252:255], v[60:63], v[112:127]
    v_cvt_pk_bf16_f32 v105, v98, v99
    v_cvt_pk_bf16_f32 v106, v100, v101
    v_cvt_pk_bf16_f32 v107, v102, v103
    buffer_store_dwordx4 v[104:107], v1, s[8:11], s60 offen sc1
    s_add_u32 s60, s60, 114688
    s_setprio 0
    s_nop 9
    v_pk_fma_f32 v[112:113], v[16:17], v[10:11], v[112:113] op_sel_hi:[1,0,1]
    v_pk_fma_f32 v[114:115], v[18:19], v[10:11], v[114:115] op_sel_hi:[1,0,1]
    v_pk_fma_f32 v[116:117], v[20:21], v[10:11], v[116:117] op_sel_hi:[1,0,1]
    v_pk_fma_f32 v[118:119], v[22:23], v[10:11], v[118:119] op_sel_hi:[1,0,1]
    v_pk_fma_f32 v[120:121], v[24:25], v[10:11], v[120:121] op_sel_hi:[1,0,1]
    v_pk_fma_f32 v[122:123], v[26:27], v[10:11], v[122:123] op_sel_hi:[1,0,1]
    v_pk_fma_f32 v[124:125], v[28:29], v[10:11], v[124:125] op_sel_hi:[1,0,1]
    v_pk_fma_f32 v[126:127], v[30:31], v[10:11], v[126:127] op_sel_hi:[1,0,1]
    v_pk_mul_f32 v[120:121], v[120:121], v[10:11] op_sel:[0,1] op_sel_hi:[1,1]
    v_pk_mul_f32 v[122:123], v[122:123], v[10:11] op_sel:[0,1] op_sel_hi:[1,1]
    v_pk_mul_f32 v[124:125], v[124:125], v[10:11] op_sel:[0,1] op_sel_hi:[1,1]
    v_pk_mul_f32 v[126:127], v[126:127], v[10:11] op_sel:[0,1] op_sel_hi:[1,1]
    v_max_f32 v112, 0, v112
    v_max_f32 v113, 0, v113
    v_max_f32 v114, 0, v114
    v_max_f32 v115, 0, v115
    v_max_f32 v116, 0, v116
    v_max_f32 v117, 0, v117
    v_max_f32 v118, 0, v118
    v_max_f32 v119, 0, v119
    v_pk_mul_f32 v[112:113], v[112:113], v[120:121]
    v_pk_mul_f32 v[114:115], v[114:115], v[122:123]
    v_pk_mul_f32 v[116:117], v[116:117], v[124:125]
    v_pk_mul_f32 v[118:119], v[118:119], v[126:127]
    v_cvt_pk_bf16_f32 v120, v112, v113
    v_cvt_pk_bf16_f32 v121, v114, v115
    v_cvt_pk_bf16_f32 v122, v116, v117
    v_cvt_pk_bf16_f32 v123, v118, v119
    buffer_store_dwordx4 v[120:123], v1, s[8:11], s60 offen sc1
    s_add_u32 s75, s76, 12288
    buffer_load_dwordx4 v[224:227], v1, s[8:11], s75 offen offset:0 sc1
    s_add_u32 s75, s76, 126976
    buffer_load_dwordx4 v[228:231], v1, s[8:11], s75 offen offset:0 sc1
    s_add_u32 s75, s76, 12288
    buffer_load_dwordx4 v[232:235], v1, s[8:11], s75 offen offset:1024 sc1
    s_add_u32 s75, s76, 126976
    buffer_load_dwordx4 v[236:239], v1, s[8:11], s75 offen offset:1024 sc1
    s_branch p4join_93
help_92:
    s_add_u32 m0, s63, 8192
    s_add_u32 s64, s62, 8192
    buffer_load_dwordx4 v1, s[8:11], s64 offen sc1 lds
    s_add_u32 m0, s63, 40960
    s_add_u32 s64, s62, 40960
    buffer_load_dwordx4 v1, s[8:11], s64 offen sc1 lds
    s_add_u32 m0, s63, 73728
    s_add_u32 s64, s62, 73728
    buffer_load_dwordx4 v1, s[8:11], s64 offen sc1 lds
    s_add_u32 m0, s63, 106496
    s_add_u32 s64, s62, 106496
    buffer_load_dwordx4 v1, s[8:11], s64 offen sc1 lds
    s_add_u32 m0, s63, 16384
    s_add_u32 s64, s62, 16384
    buffer_load_dwordx4 v1, s[8:11], s64 offen sc1 lds
    s_add_u32 m0, s63, 49152
    s_add_u32 s64, s62, 49152
    buffer_load_dwordx4 v1, s[8:11], s64 offen sc1 lds
    s_add_u32 m0, s63, 81920
    s_add_u32 s64, s62, 81920
    buffer_load_dwordx4 v1, s[8:11], s64 offen sc1 lds
    s_add_u32 m0, s63, 114688
    s_add_u32 s64, s62, 114688
    buffer_load_dwordx4 v1, s[8:11], s64 offen sc1 lds
    s_add_u32 m0, s63, 24576
    s_add_u32 s64, s62, 24576
    buffer_load_dwordx4 v1, s[8:11], s64 offen sc1 lds
    s_add_u32 m0, s63, 57344
    s_add_u32 s64, s62, 57344
    buffer_load_dwordx4 v1, s[8:11], s64 offen sc1 lds
    s_add_u32 m0, s63, 90112
    s_add_u32 s64, s62, 90112
    buffer_load_dwordx4 v1, s[8:11], s64 offen sc1 lds
    s_add_u32 m0, s63, 122880
    s_add_u32 s64, s62, 122880
    buffer_load_dwordx4 v1, s[8:11], s64 offen sc1 lds
    v_lshlrev_b32 v3, 2, v0
    s_mul_i32 s60, s6, 896
    s_add_u32 s60, s60, 3407872
    buffer_load_dword v32, v3, s[8:11], s60 offen offset:0 sc1
    buffer_load_dword v33, v3, s[8:11], s60 offen offset:256 sc1
    buffer_load_dword v34, v3, s[8:11], s60 offen offset:512 sc1
    buffer_load_dword v35, v3, s[8:11], s60 offen offset:768 sc1
    s_add_u32 s60, s60, 14336
    buffer_load_dword v36, v3, s[8:11], s60 offen offset:0 sc1
    buffer_load_dword v37, v3, s[8:11], s60 offen offset:256 sc1
    buffer_load_dword v38, v3, s[8:11], s60 offen offset:512 sc1
    buffer_load_dword v39, v3, s[8:11], s60 offen offset:768 sc1
    s_add_u32 s60, s60, 14336
    buffer_load_dword v40, v3, s[8:11], s60 offen offset:0 sc1
    buffer_load_dword v41, v3, s[8:11], s60 offen offset:256 sc1
    buffer_load_dword v42, v3, s[8:11], s60 offen offset:512 sc1
    buffer_load_dword v43, v3, s[8:11], s60 offen offset:768 sc1
    s_add_u32 s60, s60, 14336
    buffer_load_dword v44, v3, s[8:11], s60 offen offset:0 sc1
    buffer_load_dword v45, v3, s[8:11], s60 offen offset:256 sc1
    buffer_load_dword v46, v3, s[8:11], s60 offen offset:512 sc1
    buffer_load_dword v47, v3, s[8:11], s60 offen offset:768 sc1
    s_waitcnt vmcnt(28)
    s_barrier
    v_and_b32 v2, 31, v0
    v_lshlrev_b32 v64, 3, v2
    v_add_u32 v65, 135168, v64
    ds_read_b64 v[66:67], v65 offset:0
    ds_read_b64 v[68:69], v65 offset:256
    ds_read_b64 v[70:71], v65 offset:512
    ds_read_b64 v[72:73], v65 offset:768
    ds_read_b64 v[74:75], v65 offset:1024
    ds_read_b64 v[76:77], v65 offset:1280
    ds_read_b64 v[78:79], v65 offset:1536
    ds_read_b64 v[80:81], v65 offset:1792
    s_waitcnt lgkmcnt(0)
    v_pk_add_f32 v[66:67], v[66:67], v[68:69]
    v_pk_add_f32 v[66:67], v[66:67], v[70:71]
    v_pk_add_f32 v[66:67], v[66:67], v[72:73]
    v_pk_add_f32 v[66:67], v[66:67], v[74:75]
    v_pk_add_f32 v[66:67], v[66:67], v[76:77]
    v_pk_add_f32 v[66:67], v[66:67], v[78:79]
    v_pk_add_f32 v[66:67], v[66:67], v[80:81]
    v_lshlrev_b32 v64, 5, v2
    s_lshl_b32 s60, s7, 10
    s_lshl_b32 s61, s52, 3
    s_add_u32 s60, s60, s61
    s_add_u32 s60, s60, 3342336
    s_mov_b32 exec_hi, 0
    buffer_store_dwordx2 v[66:67], v64, s[8:11], s60 offen sc1
    s_mov_b64 exec, -1
    s_waitcnt vmcnt(0)
    s_lshl_b32 s60, s5, 11
    s_add_u32 s60, s60, 23175168
    s_lshl_b32 s61, s6, 7
    s_add_u32 s60, s60, s61
    v_mov_b32 v28, s56
    v_lshlrev_b32 v29, 2, v0
    s_mov_b32 exec_hi, 0
    buffer_store_dword v28, v29, s[8:11], s60 offen sc1
    s_mov_b64 exec, -1
    s_barrier
    s_barrier
    s_lshl_b32 s60, s5, 11
    s_add_u32 s60, s60, 23175168
    v_lshlrev_b32 v2, 7, v0
    s_mov_b64 exec, 0xffff
    s_mov_b32 s79, 400000
pl_95:
    buffer_load_dword v28, v2, s[8:11], s60 offen sc1
    s_waitcnt vmcnt(0)
    v_cmp_ne_u32 vcc, s56, v28
    s_nop 4
    s_cbranch_vccz pd_94
    s_sleep 1
    s_sub_u32 s79, s79, 1
    s_cmp_lg_u32 s79, 0
    s_cbranch_scc1 pl_95
pd_94:
    s_mov_b64 exec, -1
    v_lshlrev_b32 v2, 5, v0
    s_lshl_b32 s60, s5, 12
    s_add_u32 s60, s60, 3342336
    buffer_load_dwordx4 v[8:11], v2, s[8:11], s60 offen offset:0 sc1
    buffer_load_dwordx4 v[12:15], v2, s[8:11], s60 offen offset:16 sc1
    buffer_load_dwordx4 v[16:19], v2, s[8:11], s60 offen offset:2048 sc1
    buffer_load_dwordx4 v[20:23], v2, s[8:11], s60 offen offset:2064 sc1
    s_waitcnt vmcnt(0)
    v_add_f32 v8, v8, v10
    v_add_f32 v12, v12, v14
    v_add_f32 v9, v9, v11
    v_add_f32 v13, v13, v15
    v_add_f32 v8, v8, v12
    v_add_f32 v9, v9, v13
    v_mul_f32 v8, 0x3b000000, v8
    v_mul_f32 v10, v8, v8
    v_mov_b32 v11, 0x3b000000
    v_fma_f32 v9, v9, v11, -v10
    v_max_f32 v9, 0, v9
    v_add_f32 v9, 0x3727c5ac, v9
    v_rcp_f32 v9, v9
    v_sub_f32 v8, 0, v8
    v_add_f32 v16, v16, v18
    v_add_f32 v20, v20, v22
    v_add_f32 v17, v17, v19
    v_add_f32 v21, v21, v23
    v_add_f32 v16, v16, v20
    v_add_f32 v17, v17, v21
    v_mul_f32 v16, 0x3b000000, v16
    v_mul_f32 v18, v16, v16
    v_mov_b32 v19, 0x3b000000
    v_fma_f32 v17, v17, v19, -v18
    v_max_f32 v17, 0, v17
    v_add_f32 v17, 0x3727c5ac, v17
    v_rcp_f32 v17, v17
    v_sub_f32 v16, 0, v16
    v_lshlrev_b32 v4, 3, v0
    v_add_u32 v4, 131072, v4
    ds_write_b64 v4, v[8:9]
    ds_write_b64 v4, v[16:17] offset:512
    v_add_f32 v32, v32, v36
    v_add_f32 v40, v40, v44
    v_add_f32 v32, v32, v40
    v_add_f32 v33, v33, v37
    v_add_f32 v41, v41, v45
    v_add_f32 v33, v33, v41
    v_add_f32 v34, v34, v38
    v_add_f32 v42, v42, v46
    v_add_f32 v34, v34, v42
    v_add_f32 v35, v35, v39
    v_add_f32 v43, v43, v47
    v_add_f32 v35, v35, v43
    v_add_u32 v3, 132096, v3
    ds_write_b32 v3, v32 offset:0
    ds_write_b32 v3, v33 offset:256
    ds_write_b32 v3, v34 offset:512
    s_mov_b32 exec_hi, 0
    ds_write_b32 v3, v35 offset:768
    s_mov_b64 exec, -1
    s_waitcnt lgkmcnt(0)
    s_barrier
    s_add_u32 s75, s76, 0
    buffer_load_dwordx4 v[128:131], v1, s[8:11], s75 offen offset:0 sc1
    s_add_u32 s75, s76, 114688
    buffer_load_dwordx4 v[132:135], v1, s[8:11], s75 offen offset:0 sc1
    s_add_u32 s75, s76, 0
    buffer_load_dwordx4 v[136:139], v1, s[8:11], s75 offen offset:1024 sc1
    s_add_u32 s75, s76, 114688
    buffer_load_dwordx4 v[140:143], v1, s[8:11], s75 offen offset:1024 sc1
    s_add_u32 s75, s76, 0
    buffer_load_dwordx4 v[144:147], v1, s[8:11], s75 offen offset:2048 sc1
    s_add_u32 s75, s76, 114688
    buffer_load_dwordx4 v[148:151], v1, s[8:11], s75 offen offset:2048 sc1
    s_add_u32 s75, s76, 0
    buffer_load_dwordx4 v[152:155], v1, s[8:11], s75 offen offset:3072 sc1
    s_add_u32 s75, s76, 114688
    buffer_load_dwordx4 v[156:159], v1, s[8:11], s75 offen offset:3072 sc1
    s_add_u32 s75, s76, 4096
    buffer_load_dwordx4 v[160:163], v1, s[8:11], s75 offen offset:0 sc1
    s_add_u32 s75, s76, 118784
    buffer_load_dwordx4 v[164:167], v1, s[8:11], s75 offen offset:0 sc1
    s_add_u32 s75, s76, 4096
    buffer_load_dwordx4 v[168:171], v1, s[8:11], s75 offen offset:1024 sc1
    s_add_u32 s75, s76, 118784
    buffer_load_dwordx4 v[172:175], v1, s[8:11], s75 offen offset:1024 sc1
    s_add_u32 s75, s76, 4096
    buffer_load_dwordx4 v[176:179], v1, s[8:11], s75 offen offset:2048 sc1
    s_add_u32 s75, s76, 118784
    buffer_load_dwordx4 v[180:183], v1, s[8:11], s75 offen offset:2048 sc1
    s_add_u32 s75, s76, 4096
    buffer_load_dwordx4 v[184:187], v1, s[8:11], s75 offen offset:3072 sc1
    s_add_u32 s75, s76, 118784
    buffer_load_dwordx4 v[188:191], v1, s[8:11], s75 offen offset:3072 sc1
    s_add_u32 s75, s76, 8192
    buffer_load_dwordx4 v[192:195], v1, s[8:11], s75 offen offset:0 sc1
    s_add_u32 s75, s76, 122880
    buffer_load_dwordx4 v[196:199], v1, s[8:11], s75 offen offset:0 sc1
    s_add_u32 s75, s76, 8192
    buffer_load_dwordx4 v[200:203], v1, s[8:11], s75 offen offset:1024 sc1
    s_add_u32 s75, s76, 122880
    buffer_load_dwordx4 v[204:207], v1, s[8:11], s75 offen offset:1024 sc1
    s_add_u32 s75, s76, 8192
    buffer_load_dwordx4 v[208:211], v1, s[8:11], s75 offen offset:2048 sc1
    s_add_u32 s75, s76, 122880
    buffer_load_dwordx4 v[212:215], v1, s[8:11], s75 offen offset:2048 sc1
    s_add_u32 s75, s76, 8192
    buffer_load_dwordx4 v[216:219], v1, s[8:11], s75 offen offset:3072 sc1
    s_add_u32 s75, s76, 122880
    buffer_load_dwordx4 v[220:223], v1, s[8:11], s75 offen offset:3072 sc1
    s_add_u32 s75, s76, 12288
    buffer_load_dwordx4 v[224:227], v1, s[8:11], s75 offen offset:0 sc1
    s_add_u32 s75, s76, 126976
    buffer_load_dwordx4 v[228:231], v1, s[8:11], s75 offen offset:0 sc1
    s_add_u32 s75, s76, 12288
    buffer_load_dwordx4 v[232:235], v1, s[8:11], s75 offen offset:1024 sc1
    s_add_u32 s75, s76, 126976
    buffer_load_dwordx4 v[236:239], v1, s[8:11], s75 offen offset:1024 sc1
p4join_93:
    s_lshl_b32 s60, s5, 4
    s_add_u32 s60, s60, s6
    s_lshl_b32 s60, s60, 7
    s_add_u32 s60, s60, 23789568
    v_mov_b32 v28, s56
    v_lshlrev_b32 v29, 2, v0
    s_waitcnt vmcnt(4)
    s_barrier
    s_cmp_lg_u32 s4, 0
    s_cbranch_scc1 pub_96
    s_mov_b32 exec_hi, 0
    s_cmp_eq_u32 s69, 1
    s_cbranch_scc1 gl_97
    buffer_store_dword v28, v29, s[8:11], s60 offen sc1
    s_branch ge_98
gl_97:
    buffer_store_dword v28, v29, s[8:11], s60 offen
ge_98:
    s_mov_b64 exec, -1
pub_96:
    s_mov_b32 s12, s34
    s_mov_b32 s13, s35
    s_mov_b32 s14, 0x200000
    s_mov_b32 s15, 0x00020000
    s_lshr_b32 s72, s6, 3
    s_lshl_b32 s61, s5, 2
    s_lshl_b32 s62, s72, 1
    s_add_u32 s61, s61, s62
    s_mul_i32 s62, s4, 14336
    s_mul_i32 s64, s72, 229376
    s_lshl_b32 s63, s5, 19
    s_add_u32 s64, s64, s63
    s_add_u32 s64, s64, s62
    s_add_u32 s64, s64, 13631488
    s_add_u32 s65, s64, 114688
    v_lshrrev_b32 v2, 3, v0
    s_lshl_b32 s62, s4, 3
    v_add_u32 v2, s62, v2
    v_and_b32 v3, 7, v0
    v_lshrrev_b32 v4, 5, v2
    v_lshlrev_b32 v4, 5, v4
    v_lshrrev_b32 v5, 1, v3
    v_add_u32 v4, v4, v5
    v_lshlrev_b32 v4, 10, v4
    v_and_b32 v5, 1, v3
    v_lshlrev_b32 v5, 5, v5
    v_and_b32 v6, 31, v2
    v_add_u32 v5, v5, v6
    v_lshl_add_u32 v4, v5, 4, v4
    s_lshl_b32 s62, s61, 5
    s_lshl_b32 s63, s77, 2
    s_add_u32 s62, s62, s63
    s_lshl_b32 s62, s62, 10
    s_add_u32 s62, s62, 5242880
    s_mov_b32 s59, s62
    v_mov_b32 v7, v4
    v_and_b32 v16, 31, v0
    v_lshrrev_b32 v17, 5, v0
    v_lshlrev_b32 v17, 1, v17
    v_and_b32 v18, 7, v16
    v_xor_b32 v17, v17, v18
    v_lshlrev_b32 v16, 8, v16
    s_lshl_b32 s62, s4, 14
    v_add_u32 v16, s62, v16
    v_xor_b32 v12, 0, v17
    v_lshl_add_u32 v12, v12, 4, v16
    v_xor_b32 v13, 1, v17
    v_lshl_add_u32 v13, v13, 4, v16
    v_xor_b32 v14, 4, v17
    v_lshl_add_u32 v14, v14, 4, v16
    v_xor_b32 v15, 5, v17
    v_lshl_add_u32 v15, v15, 4, v16
    v_and_b32 v16, 7, v2
    v_lshlrev_b32 v17, 1, v3
    v_xor_b32 v4, v17, v16
    v_or_b32 v17, 1, v17
    v_xor_b32 v5, v17, v16
    v_lshlrev_b32 v4, 4, v4
    v_lshlrev_b32 v5, 4, v5
    v_lshl_add_u32 v4, v2, 8, v4
    v_lshl_add_u32 v5, v2, 8, v5
    v_lshlrev_b32 v16, 10, v2
    v_lshl_add_u32 v3, v3, 4, v16
    s_lshl_b32 s57, s5, 17
    s_lshl_b32 s63, s72, 16
    s_add_u32 s57, s57, s63
    s_lshl_b32 s63, s77, 7
    s_add_u32 s57, s57, s63
    s_cmp_lg_u32 s4, 7
    s_cbranch_scc1 wt_99
    s_lshl_b32 s60, s5, 4
    s_lshl_b32 s60, s60, 7
    s_add_u32 s60, s60, 23789568
    v_lshlrev_b32 v29, 7, v0
    s_mov_b64 exec, 0xffff
    s_mov_b32 s79, 400000
pl_101:
    buffer_load_dword v28, v29, s[8:11], s60 offen sc1
    s_waitcnt vmcnt(0)
    v_cmp_ne_u32 vcc, s56, v28
    s_nop 4
    s_cbranch_vccz pd_100
    s_sleep 1
    s_sub_u32 s79, s79, 1
    s_cmp_lg_u32 s79, 0
    s_cbranch_scc1 pl_101
pd_100:
    s_mov_b64 exec, -1
wt_99:
    s_barrier
    buffer_load_dwordx4 v[8:11], v7, s[8:11], s59 offen sc1
    s_mov_b32 s62, s64
    s_mov_b32 s63, s65
    buffer_load_dwordx4 v[16:19], v1, s[8:11], s64 offen offset:0 sc1
    buffer_load_dwordx4 v[20:23], v1, s[8:11], s65 offen offset:0 sc1
    buffer_load_dwordx4 v[24:27], v1, s[8:11], s64 offen offset:1024 sc1
    buffer_load_dwordx4 v[28:31], v1, s[8:11], s65 offen offset:1024 sc1
    buffer_load_dwordx4 v[32:35], v1, s[8:11], s64 offen offset:2048 sc1
    buffer_load_dwordx4 v[36:39], v1, s[8:11], s65 offen offset:2048 sc1
    buffer_load_dwordx4 v[40:43], v1, s[8:11], s64 offen offset:3072 sc1
    buffer_load_dwordx4 v[44:47], v1, s[8:11], s65 offen offset:3072 sc1
    s_add_u32 s64, s64, 4096
    s_add_u32 s65, s65, 4096
    buffer_load_dwordx4 v[48:51], v1, s[8:11], s64 offen offset:0 sc1
    buffer_load_dwordx4 v[52:55], v1, s[8:11], s65 offen offset:0 sc1
    buffer_load_dwordx4 v[56:59], v1, s[8:11], s64 offen offset:1024 sc1
    buffer_load_dwordx4 v[60:63], v1, s[8:11], s65 offen offset:1024 sc1
    buffer_load_dwordx4 v[240:243], v1, s[8:11], s64 offen offset:2048 sc1
    buffer_load_dwordx4 v[244:247], v1, s[8:11], s65 offen offset:2048 sc1
    buffer_load_dwordx4 v[248:251], v1, s[8:11], s64 offen offset:3072 sc1
    buffer_load_dwordx4 v[252:255], v1, s[8:11], s65 offen offset:3072 sc1
    s_waitcnt vmcnt(14)
    v_mfma_f32_32x32x16_bf16 v[64:79], v[128:131], v[16:19], 0
    v_mfma_f32_32x32x16_bf16 v[80:95], v[128:131], v[20:23], 0
    v_mfma_f32_32x32x16_bf16 v[96:111], v[132:135], v[16:19], 0
    v_mfma_f32_32x32x16_bf16 v[112:127], v[132:135], v[20:23], 0
    s_add_u32 s64, s64, 4096
    s_add_u32 s65, s65, 4096
    buffer_load_dwordx4 v[16:19], v1, s[8:11], s64 offen offset:0 sc1
    buffer_load_dwordx4 v[20:23], v1, s[8:11], s65 offen offset:0 sc1
    s_waitcnt vmcnt(14)
    v_mfma_f32_32x32x16_bf16 v[64:79], v[136:139], v[24:27], v[64:79]
    v_mfma_f32_32x32x16_bf16 v[80:95], v[136:139], v[28:31], v[80:95]
    v_mfma_f32_32x32x16_bf16 v[96:111], v[140:143], v[24:27], v[96:111]
    v_mfma_f32_32x32x16_bf16 v[112:127], v[140:143], v[28:31], v[112:127]
    buffer_load_dwordx4 v[24:27], v1, s[8:11], s64 offen offset:1024 sc1
    buffer_load_dwordx4 v[28:31], v1, s[8:11], s65 offen offset:1024 sc1
    s_waitcnt vmcnt(14)
    v_mfma_f32_32x32x16_bf16 v[64:79], v[144:147], v[32:35], v[64:79]
    v_mfma_f32_32x32x16_bf16 v[80:95], v[144:147], v[36:39], v[80:95]
    v_mfma_f32_32x32x16_bf16 v[96:111], v[148:151], v[32:35], v[96:111]
    v_mfma_f32_32x32x16_bf16 v[112:127], v[148:151], v[36:39], v[112:127]
    buffer_load_dwordx4 v[32:35], v1, s[8:11], s64 offen offset:2048 sc1
    buffer_load_dwordx4 v[36:39], v1, s[8:11], s65 offen offset:2048 sc1
    s_waitcnt vmcnt(14)
    v_mfma_f32_32x32x16_bf16 v[64:79], v[152:155], v[40:43], v[64:79]
    v_mfma_f32_32x32x16_bf16 v[80:95], v[152:155], v[44:47], v[80:95]
    v_mfma_f32_32x32x16_bf16 v[96:111], v[156:159], v[40:43], v[96:111]
    v_mfma_f32_32x32x16_bf16 v[112:127], v[156:159], v[44:47], v[112:127]
    buffer_load_dwordx4 v[40:43], v1, s[8:11], s64 offen offset:3072 sc1
    buffer_load_dwordx4 v[44:47], v1, s[8:11], s65 offen offset:3072 sc1
    s_waitcnt vmcnt(14)
    v_mfma_f32_32x32x16_bf16 v[64:79], v[160:163], v[48:51], v[64:79]
    v_mfma_f32_32x32x16_bf16 v[80:95], v[160:163], v[52:55], v[80:95]
    v_mfma_f32_32x32x16_bf16 v[96:111], v[164:167], v[48:51], v[96:111]
    v_mfma_f32_32x32x16_bf16 v[112:127], v[164:167], v[52:55], v[112:127]
    s_add_u32 s64, s64, 4096
    s_add_u32 s65, s65, 4096
    buffer_load_dwordx4 v[48:51], v1, s[8:11], s64 offen offset:0 sc1
    buffer_load_dwordx4 v[52:55], v1, s[8:11], s65 offen offset:0 sc1
    s_waitcnt vmcnt(14)
    v_mfma_f32_32x32x16_bf16 v[64:79], v[168:171], v[56:59], v[64:79]
    v_mfma_f32_32x32x16_bf16 v[80:95], v[168:171], v[60:63], v[80:95]
    v_mfma_f32_32x32x16_bf16 v[96:111], v[172:175], v[56:59], v[96:111]
    v_mfma_f32_32x32x16_bf16 v[112:127], v[172:175], v[60:63], v[112:127]
    buffer_load_dwordx4 v[56:59], v1, s[8:11], s64 offen offset:1024 sc1
    buffer_load_dwordx4 v[60:63], v1, s[8:11], s65 offen offset:1024 sc1
    s_waitcnt vmcnt(14)
    v_mfma_f32_32x32x16_bf16 v[64:79], v[176:179], v[240:243], v[64:79]
    v_mfma_f32_32x32x16_bf16 v[80:95], v[176:179], v[244:247], v[80:95]
    v_mfma_f32_32x32x16_bf16 v[96:111], v[180:183], v[240:243], v[96:111]
    v_mfma_f32_32x32x16_bf16 v[112:127], v[180:183], v[244:247], v[112:127]
    s_waitcnt vmcnt(12)
    v_mfma_f32_32x32x16_bf16 v[64:79], v[184:187], v[248:251], v[64:79]
    v_mfma_f32_32x32x16_bf16 v[80:95], v[184:187], v[252:255], v[80:95]
    v_mfma_f32_32x32x16_bf16 v[96:111], v[188:191], v[248:251], v[96:111]
    v_mfma_f32_32x32x16_bf16 v[112:127], v[188:191], v[252:255], v[112:127]
    s_waitcnt vmcnt(10)
    v_mfma_f32_32x32x16_bf16 v[64:79], v[192:195], v[16:19], v[64:79]
    v_mfma_f32_32x32x16_bf16 v[80:95], v[192:195], v[20:23], v[80:95]
    v_mfma_f32_32x32x16_bf16 v[96:111], v[196:199], v[16:19], v[96:111]
    v_mfma_f32_32x32x16_bf16 v[112:127], v[196:199], v[20:23], v[112:127]
    s_waitcnt vmcnt(8)
    v_mfma_f32_32x32x16_bf16 v[64:79], v[200:203], v[24:27], v[64:79]
    v_mfma_f32_32x32x16_bf16 v[80:95], v[200:203], v[28:31], v[80:95]
    v_mfma_f32_32x32x16_bf16 v[96:111], v[204:207], v[24:27], v[96:111]
    v_mfma_f32_32x32x16_bf16 v[112:127], v[204:207], v[28:31], v[112:127]
    s_waitcnt vmcnt(6)
    v_mfma_f32_32x32x16_bf16 v[64:79], v[208:211], v[32:35], v[64:79]
    v_mfma_f32_32x32x16_bf16 v[80:95], v[208:211], v[36:39], v[80:95]
    v_mfma_f32_32x32x16_bf16 v[96:111], v[212:215], v[32:35], v[96:111]
    v_mfma_f32_32x32x16_bf16 v[112:127], v[212:215], v[36:39], v[112:127]
    s_waitcnt vmcnt(4)
    v_mfma_f32_32x32x16_bf16 v[64:79], v[216:219], v[40:43], v[64:79]
    v_mfma_f32_32x32x16_bf16 v[80:95], v[216:219], v[44:47], v[80:95]
    v_mfma_f32_32x32x16_bf16 v[96:111], v[220:223], v[40:43], v[96:111]
    v_mfma_f32_32x32x16_bf16 v[112:127], v[220:223], v[44:47], v[112:127]
    s_waitcnt vmcnt(2)
    v_mfma_f32_32x32x16_bf16 v[64:79], v[224:227], v[48:51], v[64:79]
    v_mfma_f32_32x32x16_bf16 v[80:95], v[224:227], v[52:55], v[80:95]
    v_mfma_f32_32x32x16_bf16 v[96:111], v[228:231], v[48:51], v[96:111]
    v_mfma_f32_32x32x16_bf16 v[112:127], v[228:231], v[52:55], v[112:127]
    s_waitcnt vmcnt(0)
    v_mfma_f32_32x32x16_bf16 v[64:79], v[232:235], v[56:59], v[64:79]
    v_mfma_f32_32x32x16_bf16 v[80:95], v[232:235], v[60:63], v[80:95]
    v_mfma_f32_32x32x16_bf16 v[96:111], v[236:239], v[56:59], v[96:111]
    v_mfma_f32_32x32x16_bf16 v[112:127], v[236:239], v[60:63], v[112:127]
    s_setprio 0
    s_nop 8
    ds_write_b128 v12, v[64:67] offset:0
    ds_write_b128 v13, v[68:71] offset:0
    ds_write_b128 v14, v[72:75] offset:0
    ds_write_b128 v15, v[76:79] offset:0
    ds_write_b128 v12, v[80:83] offset:8192
    ds_write_b128 v13, v[84:87] offset:8192
    ds_write_b128 v14, v[88:91] offset:8192
    ds_write_b128 v15, v[92:95] offset:8192
    ds_write_b128 v12, v[96:99] offset:128
    ds_write_b128 v13, v[100:103] offset:128
    ds_write_b128 v14, v[104:107] offset:128
    ds_write_b128 v15, v[108:111] offset:128
    ds_write_b128 v12, v[112:115] offset:8320
    ds_write_b128 v13, v[116:119] offset:8320
    ds_write_b128 v14, v[120:123] offset:8320
    ds_write_b128 v15, v[124:127] offset:8320
    s_waitcnt lgkmcnt(0)
    s_barrier
    v_add_u32 v6, 65536, v4
    v_add_u32 v7, 65536, v5
    ds_read_b128 v[16:19], v4 offset:0
    ds_read_b128 v[20:23], v5 offset:0
    ds_read_b128 v[24:27], v4 offset:16384
    ds_read_b128 v[28:31], v5 offset:16384
    ds_read_b128 v[32:35], v4 offset:32768
    ds_read_b128 v[36:39], v5 offset:32768
    ds_read_b128 v[40:43], v4 offset:49152
    ds_read_b128 v[44:47], v5 offset:49152
    s_waitcnt lgkmcnt(4)
    ds_read_b128 v[48:51], v6 offset:0
    ds_read_b128 v[52:55], v7 offset:0
    ds_read_b128 v[56:59], v6 offset:16384
    ds_read_b128 v[60:63], v7 offset:16384
    ds_read_b128 v[64:67], v6 offset:32768
    ds_read_b128 v[68:71], v7 offset:32768
    ds_read_b128 v[72:75], v6 offset:49152
    ds_read_b128 v[76:79], v7 offset:49152
    s_mov_b32 s62, 0xffff0000
    v_lshlrev_b32 v80, 16, v8
    v_and_b32 v81, s62, v8
    v_lshlrev_b32 v82, 16, v9
    v_and_b32 v83, s62, v9
    v_lshlrev_b32 v84, 16, v10
    v_and_b32 v85, s62, v10
    v_lshlrev_b32 v86, 16, v11
    v_and_b32 v87, s62, v11
    s_waitcnt lgkmcnt(0)
    v_pk_add_f32 v[16:17], v[16:17], v[24:25]
    v_pk_add_f32 v[18:19], v[18:19], v[26:27]
    v_pk_add_f32 v[20:21], v[20:21], v[28:29]
    v_pk_add_f32 v[22:23], v[22:23], v[30:31]
    v_pk_add_f32 v[16:17], v[16:17], v[32:33]
    v_pk_add_f32 v[18:19], v[18:19], v[34:35]
    v_pk_add_f32 v[20:21], v[20:21], v[36:37]
    v_pk_add_f32 v[22:23], v[22:23], v[38:39]
    v_pk_add_f32 v[16:17], v[16:17], v[40:41]
    v_pk_add_f32 v[18:19], v[18:19], v[42:43]
    v_pk_add_f32 v[20:21], v[20:21], v[44:45]
    v_pk_add_f32 v[22:23], v[22:23], v[46:47]
    v_pk_add_f32 v[16:17], v[16:17], v[48:49]
    v_pk_add_f32 v[18:19], v[18:19], v[50:51]
    v_pk_add_f32 v[20:21], v[20:21], v[52:53]
    v_pk_add_f32 v[22:23], v[22:23], v[54:55]
    v_pk_add_f32 v[16:17], v[16:17], v[56:57]
    v_pk_add_f32 v[18:19], v[18:19], v[58:59]
    v_pk_add_f32 v[20:21], v[20:21], v[60:61]
    v_pk_add_f32 v[22:23], v[22:23], v[62:63]
    v_pk_add_f32 v[16:17], v[16:17], v[64:65]
    v_pk_add_f32 v[18:19], v[18:19], v[66:67]
    v_pk_add_f32 v[20:21], v[20:21], v[68:69]
    v_pk_add_f32 v[22:23], v[22:23], v[70:71]
    v_pk_add_f32 v[16:17], v[16:17], v[72:73]
    v_pk_add_f32 v[18:19], v[18:19], v[74:75]
    v_pk_add_f32 v[20:21], v[20:21], v[76:77]
    v_pk_add_f32 v[22:23], v[22:23], v[78:79]
    v_pk_add_f32 v[16:17], v[16:17], v[80:81]
    v_pk_add_f32 v[18:19], v[18:19], v[82:83]
    v_pk_add_f32 v[20:21], v[20:21], v[84:85]
    v_pk_add_f32 v[22:23], v[22:23], v[86:87]
    v_cvt_pk_bf16_f32 v8, v16, v17
    v_cvt_pk_bf16_f32 v9, v18, v19
    v_cvt_pk_bf16_f32 v10, v20, v21
    v_cvt_pk_bf16_f32 v11, v22, v23
    buffer_store_dwordx4 v[8:11], v3, s[12:15], s57 offen
    s_cmp_lg_u32 s2, 0
    s_cbranch_scc1 nn_102
    s_cmp_lg_u32 s4, 0
    s_cbranch_scc1 nn_102
    s_mov_b32 s62, 24051712
    v_mov_b32 v28, s56
    v_lshlrev_b32 v29, 2, v0
    s_mov_b32 exec_hi, 0
    buffer_store_dword v28, v29, s[8:11], s62 offen sc1
    s_mov_b64 exec, -1
nn_102:
L_fin:
    s_endpgm
.section .rodata,"a"
.p2align 6
.amdhsa_kernel sequential_preLN__grouped_kv_mqa__glu_gated_reglu__prompt_kernel
  .amdhsa_next_free_vgpr 256
  .amdhsa_next_free_sgpr 102
  .amdhsa_accum_offset 256
  .amdhsa_group_segment_fixed_size 0
  .amdhsa_kernarg_size 96
  .amdhsa_user_sgpr_count 2
  .amdhsa_user_sgpr_kernarg_segment_ptr 1
  .amdhsa_system_sgpr_workgroup_id_x 1
  .amdhsa_float_denorm_mode_32 3
.end_amdhsa_kernel
```
